```python
import torch

def _softmax(x, axis=-1):
    return torch.softmax(x, dim=axis)
def _gelu(x):
    return torch.nn.functional.gelu(x, approximate="tanh")
def _silu(x):
    return torch.nn.functional.silu(x)
def _sigmoid(x):
    return torch.sigmoid(x)
def _layernorm(x, axis=-1, eps=1e-5):
    m = x.mean(dim=axis, keepdim=True)
    v = x.var(dim=axis, keepdim=True, unbiased=False)
    return (x - m) / torch.sqrt(v + eps)
def _scatter_add(tgt, idx, src, axis=0):
    return tgt.clone().index_add_(axis, idx, src)
def _segment_sum(src, seg, n):
    out = torch.zeros((n,) + src.shape[1:], dtype=src.dtype)
    return out.index_add_(0, seg, src)
def _pad(x, pw):
    flat = tuple(v for pair in reversed(pw) for v in pair)
    return torch.nn.functional.pad(x, flat)

kernel_name = 'sequential_preLN__gqa_block_cached__glu_gated_geglu__decode'

def setup_inputs():

    _w = (lambda a: (lambda t: t.to(torch.bfloat16) if t.is_floating_point() else t)(torch.as_tensor(a)))
    def _A_setup():
        B, Sq, D = 1, 1, 512
        Hq, Hkv, Sk, Dh = 32, 8, 32768, 128
        assert Hq % Hkv == 0, (Hq, Hkv)
        return {
            "x": _w((lambda *s: torch.randn(*s, dtype=torch.bfloat16) * 0.05)(B, Sq, D)),
            "k_cache": _w((lambda *s: torch.randn(*s, dtype=torch.bfloat16) * 3.2)(B, Hkv, Sk, Dh)),
            "v_cache": _w((lambda *s: torch.randn(*s, dtype=torch.bfloat16) * 1.6)(B, Hkv, Sk, Dh)),
            "wq": _w((lambda *s: torch.randn(*s, dtype=torch.bfloat16) * 3.2)(D, Hq * Dh) * (D ** -0.5)),
            "wo": _w((lambda *s: torch.randn(*s, dtype=torch.bfloat16) * 1.6)(Hq * Dh, D) * ((Hq * Dh) ** -0.5)),
        }
    _A_in = _A_setup()

    def _B_setup():
        B, S, Dm, Df = 1, 1, 512, 1792
        return {
            "x": _w((lambda *s: torch.randn(*s, dtype=torch.bfloat16) * 0.05)(B, S, Dm)),
            "w_gate": _w((lambda *s: torch.randn(*s, dtype=torch.bfloat16) * 1.6)(Dm, Df) * (Dm ** -0.5)),
            "w_up": _w((lambda *s: torch.randn(*s, dtype=torch.bfloat16) * 1.6)(Dm, Df) * (Dm ** -0.5)),
            "w_down": _w((lambda *s: torch.randn(*s, dtype=torch.bfloat16) * 1.6)(Df, Dm) * (Df ** -0.5)),
        }
    _B_in = _B_setup()

    return {
        "A_x": _A_in["x"],
        "A_k_cache": _A_in["k_cache"],
        "A_v_cache": _A_in["v_cache"],
        "A_wq": _A_in["wq"],
        "A_wo": _A_in["wo"],
        "B_x": _B_in["x"],
        "B_w_gate": _B_in["w_gate"],
        "B_w_up": _B_in["w_up"],
        "B_w_down": _B_in["w_down"],
    }

def reference(A_x, A_k_cache, A_v_cache, A_wq, A_wo, B_x, B_w_gate, B_w_up, B_w_down):
    def _A_ref(x, k_cache, v_cache, wq, wo):
        B, Sq, D = x.shape
        Hq, Dh = 32, 128
        Hkv = k_cache.shape[1]
        rep = Hq // Hkv
        q = (lambda x, *d: x.permute(*d))((x @ wq).reshape(B, Sq, Hq, Dh), 0, 2, 1, 3)
        k = (lambda x, n, axis: torch.repeat_interleave(x, n, dim=axis))(k_cache, rep, axis=1)
        v = (lambda x, n, axis: torch.repeat_interleave(x, n, dim=axis))(v_cache, rep, axis=1)
        scores = torch.einsum("bhqd,bhkd->bhqk", q, k) * (Dh ** -0.5)
        p = _softmax(scores, axis=-1)
        o = torch.einsum("bhqk,bhkd->bhqd", p, v)
        return (lambda x, *d: x.permute(*d))(o, 0, 2, 1, 3).reshape(B, Sq, Hq * Dh) @ wo

    def _B_ref(x, w_gate, w_up, w_down):
        g = torch.einsum("bsd,df->bsf", x, w_gate)
        u = torch.einsum("bsd,df->bsf", x, w_up)
        h = _gelu(g) * u
        return torch.einsum("bsf,fd->bsd", h, w_down)

    x = A_x
    h = x + _A_ref(_layernorm(x, axis=-1), A_k_cache, A_v_cache, A_wq, A_wo)
    h2 = h + _B_ref(_layernorm(h, axis=-1), B_w_gate, B_w_up, B_w_down)
    return h2
```

```asm
; @launch grid=(256,1,1) block=(512,1,1) lds=56064
.amdgcn_target "amdgcn-amd-amdhsa--gfx950"
.text
.globl sequential_preLN__gqa_block_cached__glu_gated_geglu__decode_kernel
.p2align 8
.type sequential_preLN__gqa_block_cached__glu_gated_geglu__decode_kernel,@function
sequential_preLN__gqa_block_cached__glu_gated_geglu__decode_kernel:
s_cmp_ge_u32 s2, 256
s_cbranch_scc1 L_end
s_load_dwordx2 s[44:45], s[0:1], 8
v_lshrrev_b32 v1, 6, v0
v_and_b32 v0, 63, v0
v_readfirstlane_b32 s3, v1
s_mov_b32 s46, 67108864
s_mov_b32 s47, 0x20000
s_and_b32 s4, s2, 7
s_lshr_b32 s5, s2, 3
s_xor_b32 s3, s3, 4
s_and_b32 s6, s3, 3
s_cmp_lt_u32 s3, 4
s_cbranch_scc1 L_H
v_and_b32 v1, 3, v0
v_lshlrev_b32 v1, 8, v1
v_lshrrev_b32 v2, 2, v0
v_lshl_add_u32 v1, v2, 4, v1
v_lshlrev_b32 v2, 4, v0
s_lshl_b32 s7, s4, 23
s_lshl_b32 s8, s5, 18
s_add_u32 s7, s7, s8
s_lshl_b32 s8, s6, 12
s_add_u32 s7, s7, s8
s_mov_b32 s8, s7
s_waitcnt lgkmcnt(0)
buffer_load_dwordx4 v[96:99], v1, s[44:47], s8 offen offset:0 nt
buffer_load_dwordx4 v[100:103], v1, s[44:47], s8 offen offset:1024 nt
buffer_load_dwordx4 v[104:107], v1, s[44:47], s8 offen offset:2048 nt
buffer_load_dwordx4 v[108:111], v1, s[44:47], s8 offen offset:3072 nt
s_add_u32 s8, s8, 16384
buffer_load_dwordx4 v[112:115], v1, s[44:47], s8 offen offset:0 nt
buffer_load_dwordx4 v[116:119], v1, s[44:47], s8 offen offset:1024 nt
buffer_load_dwordx4 v[120:123], v1, s[44:47], s8 offen offset:2048 nt
buffer_load_dwordx4 v[124:127], v1, s[44:47], s8 offen offset:3072 nt
s_add_u32 s8, s8, 16384
buffer_load_dwordx4 v[128:131], v1, s[44:47], s8 offen offset:0 nt
buffer_load_dwordx4 v[132:135], v1, s[44:47], s8 offen offset:1024 nt
buffer_load_dwordx4 v[136:139], v1, s[44:47], s8 offen offset:2048 nt
s_load_dwordx2 s[40:41], s[0:1], 0
s_load_dwordx2 s[52:53], s[0:1], 24
s_load_dwordx2 s[80:81], s[0:1], 88
s_load_dwordx2 s[48:49], s[0:1], 16
s_load_dwordx2 s[56:57], s[0:1], 32
s_load_dwordx2 s[60:61], s[0:1], 48
s_load_dwordx2 s[64:65], s[0:1], 56
s_load_dwordx2 s[68:69], s[0:1], 64
s_load_dwordx2 s[72:73], s[0:1], 72
s_mov_b32 s42, 1024
s_mov_b32 s43, 0x20000
s_mov_b32 s54, 4194304
s_mov_b32 s55, 0x20000
s_mov_b32 s82, 268435456
s_mov_b32 s83, 0x20000
s_mov_b32 s50, 67108864
s_mov_b32 s51, 0x20000
s_mov_b32 s58, 4194304
s_mov_b32 s59, 0x20000
s_mov_b32 s62, 1835008
s_mov_b32 s63, 0x20000
s_mov_b32 s66, 1835008
s_mov_b32 s67, 0x20000
s_mov_b32 s70, 1835008
s_mov_b32 s71, 0x20000
s_mov_b32 s74, 1024
s_mov_b32 s75, 0x20000
s_waitcnt vmcnt(5)
buffer_load_dwordx4 v[140:143], v1, s[44:47], s8 offen offset:3072 nt
s_add_u32 s8, s8, 16384
s_waitcnt vmcnt(5)
buffer_load_dwordx4 v[144:147], v1, s[44:47], s8 offen offset:0 nt
s_waitcnt vmcnt(5)
buffer_load_dwordx4 v[148:151], v1, s[44:47], s8 offen offset:1024 nt
s_waitcnt vmcnt(5)
buffer_load_dwordx4 v[152:155], v1, s[44:47], s8 offen offset:2048 nt
s_waitcnt vmcnt(5)
buffer_load_dwordx4 v[156:159], v1, s[44:47], s8 offen offset:3072 nt
s_add_u32 s8, s8, 16384
s_waitcnt vmcnt(5)
buffer_load_dwordx4 v[160:163], v1, s[44:47], s8 offen offset:0 nt
s_waitcnt vmcnt(5)
buffer_load_dwordx4 v[164:167], v1, s[44:47], s8 offen offset:1024 nt
s_waitcnt vmcnt(5)
buffer_load_dwordx4 v[168:171], v1, s[44:47], s8 offen offset:2048 nt
s_waitcnt vmcnt(5)
buffer_load_dwordx4 v[172:175], v1, s[44:47], s8 offen offset:3072 nt
s_add_u32 s8, s8, 16384
s_waitcnt vmcnt(5)
buffer_load_dwordx4 v[176:179], v1, s[44:47], s8 offen offset:0 nt
s_waitcnt vmcnt(5)
buffer_load_dwordx4 v[180:183], v1, s[44:47], s8 offen offset:1024 nt
s_waitcnt vmcnt(5)
buffer_load_dwordx4 v[184:187], v1, s[44:47], s8 offen offset:2048 nt
s_waitcnt vmcnt(5)
buffer_load_dwordx4 v[188:191], v1, s[44:47], s8 offen offset:3072 nt
s_add_u32 s8, s8, 16384
s_waitcnt vmcnt(5)
buffer_load_dwordx4 v[192:195], v1, s[44:47], s8 offen offset:0 nt
s_waitcnt vmcnt(5)
buffer_load_dwordx4 v[196:199], v1, s[44:47], s8 offen offset:1024 nt
s_waitcnt vmcnt(5)
buffer_load_dwordx4 v[200:203], v1, s[44:47], s8 offen offset:2048 nt
s_waitcnt vmcnt(5)
buffer_load_dwordx4 v[204:207], v1, s[44:47], s8 offen offset:3072 nt
s_add_u32 s8, s8, 16384
s_waitcnt vmcnt(5)
buffer_load_dwordx4 v[208:211], v1, s[44:47], s8 offen offset:0 nt
s_waitcnt vmcnt(5)
buffer_load_dwordx4 v[212:215], v1, s[44:47], s8 offen offset:1024 nt
s_waitcnt vmcnt(5)
buffer_load_dwordx4 v[216:219], v1, s[44:47], s8 offen offset:2048 nt
s_waitcnt vmcnt(5)
buffer_load_dwordx4 v[220:223], v1, s[44:47], s8 offen offset:3072 nt
s_add_u32 s8, s8, 16384
s_waitcnt vmcnt(5)
buffer_load_dwordx4 v[224:227], v1, s[44:47], s8 offen offset:0 nt
s_waitcnt vmcnt(5)
buffer_load_dwordx4 v[228:231], v1, s[44:47], s8 offen offset:1024 nt
s_waitcnt vmcnt(5)
buffer_load_dwordx4 v[232:235], v1, s[44:47], s8 offen offset:2048 nt
s_waitcnt vmcnt(5)
buffer_load_dwordx4 v[236:239], v1, s[44:47], s8 offen offset:3072 nt
s_add_u32 s8, s8, 16384
s_waitcnt vmcnt(5)
buffer_load_dwordx4 v[240:243], v1, s[44:47], s8 offen offset:0 nt
s_waitcnt vmcnt(5)
buffer_load_dwordx4 v[244:247], v1, s[44:47], s8 offen offset:1024 nt
s_waitcnt vmcnt(5)
buffer_load_dwordx4 v[248:251], v1, s[44:47], s8 offen offset:2048 nt
s_waitcnt vmcnt(5)
buffer_load_dwordx4 v[252:255], v1, s[44:47], s8 offen offset:3072 nt
s_add_u32 s8, s8, 16384
s_waitcnt lgkmcnt(0)
s_barrier
s_branch L_S
L_H:
s_load_dwordx2 s[40:41], s[0:1], 0
s_load_dwordx2 s[52:53], s[0:1], 24
s_load_dwordx2 s[80:81], s[0:1], 88
s_load_dwordx2 s[48:49], s[0:1], 16
s_load_dwordx2 s[56:57], s[0:1], 32
s_load_dwordx2 s[60:61], s[0:1], 48
s_load_dwordx2 s[64:65], s[0:1], 56
s_load_dwordx2 s[68:69], s[0:1], 64
s_load_dwordx2 s[72:73], s[0:1], 72
s_mov_b32 s42, 1024
s_mov_b32 s43, 0x20000
s_mov_b32 s54, 4194304
s_mov_b32 s55, 0x20000
s_mov_b32 s82, 268435456
s_mov_b32 s83, 0x20000
s_mov_b32 s50, 67108864
s_mov_b32 s51, 0x20000
s_mov_b32 s58, 4194304
s_mov_b32 s59, 0x20000
s_mov_b32 s62, 1835008
s_mov_b32 s63, 0x20000
s_mov_b32 s66, 1835008
s_mov_b32 s67, 0x20000
s_mov_b32 s70, 1835008
s_mov_b32 s71, 0x20000
s_mov_b32 s74, 1024
s_mov_b32 s75, 0x20000
s_and_b32 s17, s5, 7
s_lshr_b32 s18, s5, 3
s_cmp_lg_u32 s3, 0
s_cbranch_scc1 L_Hwarm
s_setprio 2
v_lshlrev_b32 v2, 4, v0
v_lshrrev_b32 v1, 3, v0
v_lshlrev_b32 v1, 13, v1
v_and_b32 v3, 7, v0
v_lshl_add_u32 v1, v3, 4, v1
s_lshl_b32 s8, s18, 20
s_lshl_b32 s10, s4, 10
s_add_u32 s8, s8, s10
s_lshl_b32 s10, s17, 7
s_add_u32 s8, s8, s10
s_mov_b32 m0, 0
s_getreg_b32 s38, hwreg(HW_REG_XCC_ID)
s_and_b32 s38, s38, 15
s_waitcnt lgkmcnt(0)
s_load_dword s33, s[80:81], 102400
buffer_load_dwordx4 v[4:7], v2, s[40:43], 0 offen
buffer_load_dwordx4 v1, s[52:55], s8 offen nt lds
s_add_u32 m0, m0, 1024
s_add_u32 s8, s8, 0x10000
buffer_load_dwordx4 v1, s[52:55], s8 offen nt lds
s_add_u32 m0, m0, 1024
s_add_u32 s8, s8, 0x10000
buffer_load_dwordx4 v1, s[52:55], s8 offen nt lds
s_add_u32 m0, m0, 1024
s_add_u32 s8, s8, 0x10000
buffer_load_dwordx4 v1, s[52:55], s8 offen nt lds
s_add_u32 m0, m0, 1024
s_add_u32 s8, s8, 0x10000
buffer_load_dwordx4 v1, s[52:55], s8 offen nt lds
s_add_u32 m0, m0, 1024
s_add_u32 s8, s8, 0x10000
buffer_load_dwordx4 v1, s[52:55], s8 offen nt lds
s_add_u32 m0, m0, 1024
s_add_u32 s8, s8, 0x10000
buffer_load_dwordx4 v1, s[52:55], s8 offen nt lds
s_add_u32 m0, m0, 1024
s_add_u32 s8, s8, 0x10000
buffer_load_dwordx4 v1, s[52:55], s8 offen nt lds
s_add_u32 m0, m0, 1024
s_add_u32 s8, s8, 0x10000
buffer_load_dwordx4 v1, s[52:55], s8 offen nt lds
s_add_u32 m0, m0, 1024
s_add_u32 s8, s8, 0x10000
buffer_load_dwordx4 v1, s[52:55], s8 offen nt lds
s_add_u32 m0, m0, 1024
s_add_u32 s8, s8, 0x10000
buffer_load_dwordx4 v1, s[52:55], s8 offen nt lds
s_add_u32 m0, m0, 1024
s_add_u32 s8, s8, 0x10000
buffer_load_dwordx4 v1, s[52:55], s8 offen nt lds
s_add_u32 m0, m0, 1024
s_add_u32 s8, s8, 0x10000
buffer_load_dwordx4 v1, s[52:55], s8 offen nt lds
s_add_u32 m0, m0, 1024
s_add_u32 s8, s8, 0x10000
buffer_load_dwordx4 v1, s[52:55], s8 offen nt lds
s_add_u32 m0, m0, 1024
s_add_u32 s8, s8, 0x10000
buffer_load_dwordx4 v1, s[52:55], s8 offen nt lds
s_add_u32 m0, m0, 1024
s_add_u32 s8, s8, 0x10000
buffer_load_dwordx4 v1, s[52:55], s8 offen nt lds
L_pad0:
s_cbranch_execz L_pad1
s_mov_b32 s12, 0xffff0000
s_waitcnt vmcnt(16)
v_lshlrev_b32 v8, 16, v4
v_and_b32 v9, s12, v4
v_lshlrev_b32 v10, 16, v5
v_and_b32 v11, s12, v5
v_lshlrev_b32 v12, 16, v6
v_and_b32 v13, s12, v6
v_lshlrev_b32 v14, 16, v7
v_and_b32 v15, s12, v7
v_add_f32 v16, v8, v9
v_add_f32 v17, v10, v11
v_add_f32 v18, v12, v13
v_add_f32 v19, v14, v15
v_add_f32 v16, v16, v17
v_add_f32 v18, v18, v19
v_add_f32 v16, v16, v18
s_nop 1
v_add_f32_dpp v16, v16, v16 row_ror:8 row_mask:0xf bank_mask:0xf
s_nop 1
v_add_f32_dpp v16, v16, v16 row_ror:4 row_mask:0xf bank_mask:0xf
s_nop 1
v_add_f32_dpp v16, v16, v16 row_ror:2 row_mask:0xf bank_mask:0xf
s_nop 1
v_add_f32_dpp v16, v16, v16 row_ror:1 row_mask:0xf bank_mask:0xf
v_mov_b32 v17, v16
s_nop 1
v_permlane16_swap_b32 v17, v16
v_add_f32 v16, v16, v17
v_mov_b32 v17, v16
s_nop 1
v_permlane32_swap_b32 v17, v16
v_add_f32 v16, v16, v17
v_mul_f32 v16, 0x3b000000, v16
v_sub_f32 v17, v8, v16
v_mul_f32 v18, v17, v17
v_sub_f32 v17, v9, v16
v_fmac_f32 v18, v17, v17
v_sub_f32 v17, v10, v16
v_fmac_f32 v18, v17, v17
v_sub_f32 v17, v11, v16
v_fmac_f32 v18, v17, v17
v_sub_f32 v17, v12, v16
v_fmac_f32 v18, v17, v17
v_sub_f32 v17, v13, v16
v_fmac_f32 v18, v17, v17
v_sub_f32 v17, v14, v16
v_fmac_f32 v18, v17, v17
v_sub_f32 v17, v15, v16
v_fmac_f32 v18, v17, v17
s_nop 1
v_add_f32_dpp v18, v18, v18 row_ror:8 row_mask:0xf bank_mask:0xf
s_nop 1
v_add_f32_dpp v18, v18, v18 row_ror:4 row_mask:0xf bank_mask:0xf
s_nop 1
v_add_f32_dpp v18, v18, v18 row_ror:2 row_mask:0xf bank_mask:0xf
s_nop 1
v_add_f32_dpp v18, v18, v18 row_ror:1 row_mask:0xf bank_mask:0xf
v_mov_b32 v17, v18
s_nop 1
v_permlane16_swap_b32 v17, v18
v_add_f32 v18, v18, v17
v_mov_b32 v17, v18
s_nop 1
v_permlane32_swap_b32 v17, v18
v_add_f32 v18, v18, v17
v_mul_f32 v18, 0x3b000000, v18
v_cvt_pk_bf16_f32 v18, v18, v18
v_lshlrev_b32 v18, 16, v18
v_add_f32 v18, 0x3727c5ac, v18
v_cvt_pk_bf16_f32 v18, v18, v18
v_lshlrev_b32 v18, 16, v18
v_sqrt_f32 v18, v18
s_nop 0
v_cvt_pk_bf16_f32 v18, v18, v18
v_lshlrev_b32 v18, 16, v18
v_rcp_f32 v18, v18
v_cvt_pk_bf16_f32 v16, v16, v16
v_lshlrev_b32 v16, 16, v16
v_sub_f32 v8, v8, v16
v_sub_f32 v9, v9, v16
v_sub_f32 v10, v10, v16
v_sub_f32 v11, v11, v16
v_sub_f32 v12, v12, v16
v_sub_f32 v13, v13, v16
v_sub_f32 v14, v14, v16
v_sub_f32 v15, v15, v16
v_cvt_pk_bf16_f32 v4, v8, v9
v_cvt_pk_bf16_f32 v5, v10, v11
v_cvt_pk_bf16_f32 v6, v12, v13
v_cvt_pk_bf16_f32 v7, v14, v15
v_lshlrev_b32 v8, 16, v4
v_and_b32 v9, s12, v4
v_lshlrev_b32 v10, 16, v5
v_and_b32 v11, s12, v5
v_lshlrev_b32 v12, 16, v6
v_and_b32 v13, s12, v6
v_lshlrev_b32 v14, 16, v7
v_and_b32 v15, s12, v7
v_mul_f32 v8, v8, v18
v_mul_f32 v9, v9, v18
v_mul_f32 v10, v10, v18
v_mul_f32 v11, v11, v18
v_mul_f32 v12, v12, v18
v_mul_f32 v13, v13, v18
v_mul_f32 v14, v14, v18
v_mul_f32 v15, v15, v18
v_cvt_pk_bf16_f32 v4, v8, v9
v_cvt_pk_bf16_f32 v5, v10, v11
v_cvt_pk_bf16_f32 v6, v12, v13
v_cvt_pk_bf16_f32 v7, v14, v15
ds_write_b128 v2, v[4:7] offset:33792
v_lshrrev_b32 v3, 4, v0
v_lshlrev_b32 v16, 4, v3
s_lshl_b32 s9, s18, 8
v_add_u32 v16, s9, v16
v_lshlrev_b32 v17, 10, v3
v_bfe_u32 v18, v0, 2, 2
v_lshl_add_u32 v17, v18, 7, v17
v_and_b32 v18, 3, v0
v_lshl_add_u32 v17, v18, 3, v17
s_waitcnt lgkmcnt(0)
ds_read_b128 v[64:67], v16 offset:33792
ds_read_b128 v[68:71], v16 offset:33856
ds_read_b128 v[72:75], v16 offset:33920
ds_read_b128 v[76:79], v16 offset:33984
s_mul_i32 s96, s33, 1664525
s_add_u32 s96, s96, 1013904223
s_and_b32 s34, s96, 1023
s_bfe_u32 s35, s96, 655370
s_bfe_u32 s36, s96, 655380
s_lshr_b32 s37, s96, 22
v_mul_u32_u24 v19, 10, v18
v_min_u32 v19, 22, v19
v_lshrrev_b32_e64 v19, v19, s96
v_cmp_eq_u32 vcc, 3, v18
v_mov_b32 v21, s38
v_mov_b32 v20, 1023
v_cndmask_b32 v21, 0, v21, vcc
v_xor_b32 v19, v19, v21
s_xor_b32 s13, s37, s38
s_waitcnt vmcnt(0) lgkmcnt(0)
L_pad1:
s_cbranch_execz L_pad2
ds_read_b64_tr_b16 v[128:129], v17 offset:0
ds_read_b64_tr_b16 v[130:131], v17 offset:512
ds_read_b64_tr_b16 v[132:133], v17 offset:32
ds_read_b64_tr_b16 v[134:135], v17 offset:544
ds_read_b64_tr_b16 v[136:137], v17 offset:64
ds_read_b64_tr_b16 v[138:139], v17 offset:576
ds_read_b64_tr_b16 v[140:141], v17 offset:96
ds_read_b64_tr_b16 v[142:143], v17 offset:608
ds_read_b64_tr_b16 v[144:145], v17 offset:4096
ds_read_b64_tr_b16 v[146:147], v17 offset:4608
s_waitcnt lgkmcnt(8)
v_mfma_f32_16x16x32_bf16 v[24:27], v[64:67], v[128:131], 0
ds_read_b64_tr_b16 v[148:149], v17 offset:4128
ds_read_b64_tr_b16 v[150:151], v17 offset:4640
s_waitcnt lgkmcnt(8)
v_mfma_f32_16x16x32_bf16 v[28:31], v[64:67], v[132:135], 0
ds_read_b64_tr_b16 v[152:153], v17 offset:4160
ds_read_b64_tr_b16 v[154:155], v17 offset:4672
s_waitcnt lgkmcnt(8)
v_mfma_f32_16x16x32_bf16 v[32:35], v[64:67], v[136:139], 0
ds_read_b64_tr_b16 v[156:157], v17 offset:4192
ds_read_b64_tr_b16 v[158:159], v17 offset:4704
s_waitcnt lgkmcnt(8)
v_mfma_f32_16x16x32_bf16 v[36:39], v[64:67], v[140:143], 0
ds_read_b64_tr_b16 v[160:161], v17 offset:8192
ds_read_b64_tr_b16 v[162:163], v17 offset:8704
s_waitcnt lgkmcnt(8)
v_mfma_f32_16x16x32_bf16 v[24:27], v[68:71], v[144:147], v[24:27]
ds_read_b64_tr_b16 v[164:165], v17 offset:8224
ds_read_b64_tr_b16 v[166:167], v17 offset:8736
s_waitcnt lgkmcnt(8)
v_mfma_f32_16x16x32_bf16 v[28:31], v[68:71], v[148:151], v[28:31]
ds_read_b64_tr_b16 v[168:169], v17 offset:8256
ds_read_b64_tr_b16 v[170:171], v17 offset:8768
s_waitcnt lgkmcnt(8)
v_mfma_f32_16x16x32_bf16 v[32:35], v[68:71], v[152:155], v[32:35]
ds_read_b64_tr_b16 v[172:173], v17 offset:8288
ds_read_b64_tr_b16 v[174:175], v17 offset:8800
s_waitcnt lgkmcnt(8)
v_mfma_f32_16x16x32_bf16 v[36:39], v[68:71], v[156:159], v[36:39]
ds_read_b64_tr_b16 v[176:177], v17 offset:12288
ds_read_b64_tr_b16 v[178:179], v17 offset:12800
s_waitcnt lgkmcnt(8)
v_mfma_f32_16x16x32_bf16 v[24:27], v[72:75], v[160:163], v[24:27]
ds_read_b64_tr_b16 v[180:181], v17 offset:12320
ds_read_b64_tr_b16 v[182:183], v17 offset:12832
s_waitcnt lgkmcnt(8)
v_mfma_f32_16x16x32_bf16 v[28:31], v[72:75], v[164:167], v[28:31]
ds_read_b64_tr_b16 v[184:185], v17 offset:12352
ds_read_b64_tr_b16 v[186:187], v17 offset:12864
s_waitcnt lgkmcnt(8)
v_mfma_f32_16x16x32_bf16 v[32:35], v[72:75], v[168:171], v[32:35]
ds_read_b64_tr_b16 v[188:189], v17 offset:12384
ds_read_b64_tr_b16 v[190:191], v17 offset:12896
s_waitcnt lgkmcnt(8)
v_mfma_f32_16x16x32_bf16 v[36:39], v[72:75], v[172:175], v[36:39]
s_waitcnt lgkmcnt(6)
v_mfma_f32_16x16x32_bf16 v[24:27], v[76:79], v[176:179], v[24:27]
s_waitcnt lgkmcnt(4)
v_mfma_f32_16x16x32_bf16 v[28:31], v[76:79], v[180:183], v[28:31]
s_waitcnt lgkmcnt(2)
v_mfma_f32_16x16x32_bf16 v[32:35], v[76:79], v[184:187], v[32:35]
s_waitcnt lgkmcnt(0)
v_mfma_f32_16x16x32_bf16 v[36:39], v[76:79], v[188:191], v[36:39]
v_lshlrev_b32 v3, 2, v0
s_lshl_b32 s9, s4, 13
s_lshl_b32 s10, s18, 11
s_add_u32 s9, s9, s10
s_lshl_b32 s10, s17, 8
s_add_u32 s9, s9, s10
s_lshl_b32 s16, s4, 13
s_add_u32 s15, s16, 4096
v_mov_b32_dpp v24, v28 quad_perm:[0,1,2,3] row_mask:2 bank_mask:0xf
s_nop 1
v_mov_b32_dpp v24, v32 quad_perm:[0,1,2,3] row_mask:4 bank_mask:0xf
s_nop 1
v_mov_b32_dpp v24, v36 quad_perm:[0,1,2,3] row_mask:8 bank_mask:0xf
v_add_u32 v24, 512, v24
v_bfi_b32 v24, v20, v19, v24
buffer_store_dword v24, v3, s[80:83], s9 offen
s_mov_b32 s14, 0
L_pad2:
s_cbranch_execz L_pad3
L_qpoll:
s_cmp_lg_u32 s14, 6
s_cbranch_scc1 L_qnr
s_mov_b64 s[22:23], exec
s_mov_b64 exec, -1
buffer_store_dword v24, v3, s[80:83], s9 offen sc1
s_mov_b64 exec, s[22:23]
L_qnr:
buffer_load_dwordx4 v[64:67], v2, s[80:83], s16 offen offset:0 sc1
buffer_load_dwordx4 v[68:71], v2, s[80:83], s16 offen offset:1024 sc1
buffer_load_dwordx4 v[72:75], v2, s[80:83], s16 offen offset:2048 sc1
buffer_load_dwordx4 v[76:79], v2, s[80:83], s16 offen offset:3072 sc1
buffer_load_dwordx4 v[80:83], v2, s[80:83], s15 offen offset:0 sc1
buffer_load_dwordx4 v[84:87], v2, s[80:83], s15 offen offset:1024 sc1
buffer_load_dwordx4 v[88:91], v2, s[80:83], s15 offen offset:2048 sc1
buffer_load_dwordx4 v[92:95], v2, s[80:83], s15 offen offset:3072 sc1
s_add_u32 s14, s14, 1
s_cmp_gt_u32 s14, 262144
s_cbranch_scc1 L_qdone
s_waitcnt vmcnt(7)
v_xor_b32 v64, s34, v64
v_xor_b32 v65, s35, v65
v_xor_b32 v66, s36, v66
v_xor_b32 v67, s13, v67
v_or3_b32 v8, v64, v65, v66
v_mov_b32 v9, v67
s_waitcnt vmcnt(6)
v_xor_b32 v68, s34, v68
v_xor_b32 v69, s35, v69
v_xor_b32 v70, s36, v70
v_xor_b32 v71, s13, v71
v_or3_b32 v8, v8, v68, v69
v_or_b32 v8, v8, v70
v_or_b32 v9, v9, v71
s_waitcnt vmcnt(5)
v_xor_b32 v72, s34, v72
v_xor_b32 v73, s35, v73
v_xor_b32 v74, s36, v74
v_xor_b32 v75, s13, v75
v_or3_b32 v8, v8, v72, v73
v_or_b32 v8, v8, v74
v_or_b32 v9, v9, v75
s_waitcnt vmcnt(4)
v_xor_b32 v76, s34, v76
v_xor_b32 v77, s35, v77
v_xor_b32 v78, s36, v78
v_xor_b32 v79, s13, v79
v_or3_b32 v8, v8, v76, v77
v_or_b32 v8, v8, v78
v_or_b32 v9, v9, v79
s_waitcnt vmcnt(3)
v_xor_b32 v80, s34, v80
v_xor_b32 v81, s35, v81
v_xor_b32 v82, s36, v82
v_xor_b32 v83, s13, v83
v_or3_b32 v8, v8, v80, v81
v_or_b32 v8, v8, v82
v_or_b32 v9, v9, v83
s_waitcnt vmcnt(2)
v_xor_b32 v84, s34, v84
v_xor_b32 v85, s35, v85
v_xor_b32 v86, s36, v86
v_xor_b32 v87, s13, v87
v_or3_b32 v8, v8, v84, v85
v_or_b32 v8, v8, v86
v_or_b32 v9, v9, v87
s_waitcnt vmcnt(1)
v_xor_b32 v88, s34, v88
v_xor_b32 v89, s35, v89
v_xor_b32 v90, s36, v90
v_xor_b32 v91, s13, v91
v_or3_b32 v8, v8, v88, v89
v_or_b32 v8, v8, v90
v_or_b32 v9, v9, v91
s_waitcnt vmcnt(0)
v_xor_b32 v92, s34, v92
v_xor_b32 v93, s35, v93
v_xor_b32 v94, s36, v94
v_xor_b32 v95, s13, v95
v_or3_b32 v8, v8, v92, v93
v_or_b32 v8, v8, v94
v_or_b32 v9, v9, v95
v_and_b32 v10, 1008, v9
v_bitop3_b32 v8, v8, v10, v20 bitop3:0xa8
v_cmp_ne_u32 vcc, 0, v8
s_and_b64 exec, exec, vcc
s_cbranch_execnz L_qpoll
L_qdone:
s_mov_b64 exec, -1
s_waitcnt vmcnt(0)
v_and_b32 v9, 15, v9
v_cmp_ne_u32 vcc, 0, v9
s_cmp_eq_u64 vcc, 0
s_cselect_b32 s39, 1, 0
v_mov_b32 v9, s39
v_mov_b32 v10, 0
ds_write_b32 v10, v9 offset:35968
s_cmp_lg_u32 s39, 0
s_cbranch_scc1 L_qsame
buffer_store_dword v24, v3, s[80:83], s9 offen sc1
L_qsame:
v_and_b32 v67, -16, v67
v_and_b32 v71, -16, v71
v_and_b32 v75, -16, v75
v_and_b32 v79, -16, v79
v_and_b32 v83, -16, v83
v_and_b32 v87, -16, v87
v_and_b32 v91, -16, v91
v_and_b32 v95, -16, v95
v_lshlrev_b32 v3, 3, v0
v_add_f32 v64, v64, v72
v_add_f32 v65, v65, v73
v_add_f32 v66, v66, v74
v_add_f32 v67, v67, v75
v_add_f32 v68, v68, v76
v_add_f32 v69, v69, v77
v_add_f32 v70, v70, v78
v_add_f32 v71, v71, v79
v_add_f32 v80, v80, v88
v_add_f32 v81, v81, v89
v_add_f32 v82, v82, v90
v_add_f32 v83, v83, v91
v_add_f32 v84, v84, v92
v_add_f32 v85, v85, v93
v_add_f32 v86, v86, v94
v_add_f32 v87, v87, v95
v_add_f32 v64, v64, v80
v_add_f32 v65, v65, v81
v_add_f32 v66, v66, v82
v_add_f32 v67, v67, v83
v_add_f32 v68, v68, v84
v_add_f32 v69, v69, v85
v_add_f32 v70, v70, v86
v_add_f32 v71, v71, v87
v_cvt_pk_bf16_f32 v4, v64, v65
v_cvt_pk_bf16_f32 v5, v66, v67
v_cvt_pk_bf16_f32 v6, v68, v69
v_cvt_pk_bf16_f32 v7, v70, v71
ds_write2st64_b64 v3, v[4:5], v[6:7] offset0:68 offset1:69
s_waitcnt lgkmcnt(0)
s_setprio 0
s_branch L_Hb1
L_Hwarm:
s_waitcnt lgkmcnt(0)
s_load_dword s33, s[80:81], 102400
s_mov_b64 exec, 0
s_cmp_eq_u32 s3, 1
s_cbranch_scc1 L_pad0
s_cmp_eq_u32 s3, 2
s_cbranch_scc1 L_pad8
s_branch L_pad16
L_warm_end:
s_mov_b64 exec, -1
s_waitcnt lgkmcnt(0)
s_mul_i32 s96, s33, 1664525
s_add_u32 s96, s96, 1013904223
s_and_b32 s34, s96, 1023
s_bfe_u32 s35, s96, 655370
s_bfe_u32 s36, s96, 655380
s_lshr_b32 s37, s96, 22
L_Hb1:
s_barrier
s_branch L_Hmid
L_S:
ds_read_b128 v[20:23], v1 offset:34816
v_mov_b32 v12, 0
ds_read_b32 v12, v12 offset:35968
s_mov_b32 s12, 0xffff0000
s_mov_b32 s13, 0x3db504f3
v_mov_b32 v3, 0xff800000
v_lshrrev_b32 v14, 4, v0
s_waitcnt lgkmcnt(0)
v_readfirstlane_b32 s39, v12
L_pad3:
s_cbranch_execz L_pad4
s_waitcnt vmcnt(36)
v_mfma_f32_4x4x4_16b_bf16 v[56:59], v[96:97], v[20:21], 0
v_mfma_f32_4x4x4_16b_bf16 v[60:63], v[100:101], v[20:21], 0
v_mfma_f32_4x4x4_16b_bf16 v[64:67], v[104:105], v[20:21], 0
v_mfma_f32_4x4x4_16b_bf16 v[68:71], v[108:109], v[20:21], 0
v_mfma_f32_4x4x4_16b_bf16 v[56:59], v[98:99], v[22:23], v[56:59]
v_mfma_f32_4x4x4_16b_bf16 v[60:63], v[102:103], v[22:23], v[60:63]
v_mfma_f32_4x4x4_16b_bf16 v[64:67], v[106:107], v[22:23], v[64:67]
v_mfma_f32_4x4x4_16b_bf16 v[68:71], v[110:111], v[22:23], v[68:71]
s_waitcnt vmcnt(5)
buffer_load_dwordx4 v[96:99], v1, s[44:47], s8 offen offset:0 nt
s_waitcnt vmcnt(5)
buffer_load_dwordx4 v[100:103], v1, s[44:47], s8 offen offset:1024 nt
s_waitcnt vmcnt(5)
buffer_load_dwordx4 v[104:107], v1, s[44:47], s8 offen offset:2048 nt
v_permlane32_swap_b32 v56, v58
v_permlane32_swap_b32 v57, v59
v_permlane32_swap_b32 v60, v62
v_permlane32_swap_b32 v61, v63
v_permlane32_swap_b32 v64, v66
v_permlane32_swap_b32 v65, v67
v_permlane32_swap_b32 v68, v70
v_permlane32_swap_b32 v69, v71
v_add_f32 v56, v56, v58
v_add_f32 v57, v57, v59
v_add_f32 v60, v60, v62
v_add_f32 v61, v61, v63
v_add_f32 v64, v64, v66
v_add_f32 v65, v65, v67
v_add_f32 v68, v68, v70
v_add_f32 v69, v69, v71
v_permlane16_swap_b32 v56, v57
v_permlane16_swap_b32 v60, v61
v_permlane16_swap_b32 v64, v65
v_permlane16_swap_b32 v68, v69
v_add_f32 v56, v56, v57
v_add_f32 v60, v60, v61
v_add_f32 v64, v64, v65
v_add_f32 v68, v68, v69
v_add_f32_dpp v57, v56, v56 row_ror:4 row_mask:0xf bank_mask:0xf
v_add_f32_dpp v61, v60, v60 row_ror:4 row_mask:0xf bank_mask:0xf
v_add_f32_dpp v65, v64, v64 row_ror:4 row_mask:0xf bank_mask:0xf
v_add_f32_dpp v69, v68, v68 row_ror:4 row_mask:0xf bank_mask:0xf
v_add_f32_dpp v56, v57, v57 row_ror:8 row_mask:0xf bank_mask:0xf
v_add_f32_dpp v60, v61, v61 row_ror:8 row_mask:0xf bank_mask:0xf
v_add_f32_dpp v64, v65, v65 row_ror:8 row_mask:0xf bank_mask:0xf
v_add_f32_dpp v68, v69, v69 row_ror:8 row_mask:0xf bank_mask:0xf
v_cvt_pk_bf16_f32 v5, v56, v60
v_cvt_pk_bf16_f32 v6, v64, v68
v_lshlrev_b32 v7, 16, v5
v_and_b32 v8, s12, v5
v_lshlrev_b32 v9, 16, v6
v_and_b32 v10, s12, v6
v_mul_f32 v7, s13, v7
v_mul_f32 v8, s13, v8
v_mul_f32 v9, s13, v9
v_mul_f32 v10, s13, v10
v_cvt_pk_bf16_f32 v24, v7, v8
v_cvt_pk_bf16_f32 v25, v9, v10
v_max3_f32 v3, v3, v7, v8
v_max3_f32 v3, v3, v9, v10
s_waitcnt vmcnt(35)
v_mfma_f32_4x4x4_16b_bf16 v[56:59], v[112:113], v[20:21], 0
v_mfma_f32_4x4x4_16b_bf16 v[60:63], v[116:117], v[20:21], 0
v_mfma_f32_4x4x4_16b_bf16 v[64:67], v[120:121], v[20:21], 0
v_mfma_f32_4x4x4_16b_bf16 v[68:71], v[124:125], v[20:21], 0
v_mfma_f32_4x4x4_16b_bf16 v[56:59], v[114:115], v[22:23], v[56:59]
v_mfma_f32_4x4x4_16b_bf16 v[60:63], v[118:119], v[22:23], v[60:63]
v_mfma_f32_4x4x4_16b_bf16 v[64:67], v[122:123], v[22:23], v[64:67]
v_mfma_f32_4x4x4_16b_bf16 v[68:71], v[126:127], v[22:23], v[68:71]
s_waitcnt vmcnt(5)
buffer_load_dwordx4 v[108:111], v1, s[44:47], s8 offen offset:3072 nt
s_add_u32 s8, s8, 16384
s_waitcnt vmcnt(5)
buffer_load_dwordx4 v[112:115], v1, s[44:47], s8 offen offset:0 nt
s_waitcnt vmcnt(5)
buffer_load_dwordx4 v[116:119], v1, s[44:47], s8 offen offset:1024 nt
v_permlane32_swap_b32 v56, v58
v_permlane32_swap_b32 v57, v59
v_permlane32_swap_b32 v60, v62
v_permlane32_swap_b32 v61, v63
v_permlane32_swap_b32 v64, v66
v_permlane32_swap_b32 v65, v67
v_permlane32_swap_b32 v68, v70
v_permlane32_swap_b32 v69, v71
v_add_f32 v56, v56, v58
v_add_f32 v57, v57, v59
v_add_f32 v60, v60, v62
v_add_f32 v61, v61, v63
v_add_f32 v64, v64, v66
v_add_f32 v65, v65, v67
v_add_f32 v68, v68, v70
v_add_f32 v69, v69, v71
v_permlane16_swap_b32 v56, v57
v_permlane16_swap_b32 v60, v61
v_permlane16_swap_b32 v64, v65
v_permlane16_swap_b32 v68, v69
v_add_f32 v56, v56, v57
v_add_f32 v60, v60, v61
v_add_f32 v64, v64, v65
v_add_f32 v68, v68, v69
v_add_f32_dpp v57, v56, v56 row_ror:4 row_mask:0xf bank_mask:0xf
v_add_f32_dpp v61, v60, v60 row_ror:4 row_mask:0xf bank_mask:0xf
v_add_f32_dpp v65, v64, v64 row_ror:4 row_mask:0xf bank_mask:0xf
v_add_f32_dpp v69, v68, v68 row_ror:4 row_mask:0xf bank_mask:0xf
v_add_f32_dpp v56, v57, v57 row_ror:8 row_mask:0xf bank_mask:0xf
v_add_f32_dpp v60, v61, v61 row_ror:8 row_mask:0xf bank_mask:0xf
v_add_f32_dpp v64, v65, v65 row_ror:8 row_mask:0xf bank_mask:0xf
v_add_f32_dpp v68, v69, v69 row_ror:8 row_mask:0xf bank_mask:0xf
v_cvt_pk_bf16_f32 v5, v56, v60
v_cvt_pk_bf16_f32 v6, v64, v68
v_lshlrev_b32 v7, 16, v5
v_and_b32 v8, s12, v5
v_lshlrev_b32 v9, 16, v6
v_and_b32 v10, s12, v6
v_mul_f32 v7, s13, v7
v_mul_f32 v8, s13, v8
v_mul_f32 v9, s13, v9
v_mul_f32 v10, s13, v10
v_cvt_pk_bf16_f32 v26, v7, v8
v_cvt_pk_bf16_f32 v27, v9, v10
v_max3_f32 v3, v3, v7, v8
v_max3_f32 v3, v3, v9, v10
L_pad4:
s_cbranch_execz L_pad5
s_waitcnt vmcnt(34)
v_mfma_f32_4x4x4_16b_bf16 v[56:59], v[128:129], v[20:21], 0
v_mfma_f32_4x4x4_16b_bf16 v[60:63], v[132:133], v[20:21], 0
v_mfma_f32_4x4x4_16b_bf16 v[64:67], v[136:137], v[20:21], 0
v_mfma_f32_4x4x4_16b_bf16 v[68:71], v[140:141], v[20:21], 0
v_mfma_f32_4x4x4_16b_bf16 v[56:59], v[130:131], v[22:23], v[56:59]
v_mfma_f32_4x4x4_16b_bf16 v[60:63], v[134:135], v[22:23], v[60:63]
v_mfma_f32_4x4x4_16b_bf16 v[64:67], v[138:139], v[22:23], v[64:67]
v_mfma_f32_4x4x4_16b_bf16 v[68:71], v[142:143], v[22:23], v[68:71]
s_waitcnt vmcnt(5)
buffer_load_dwordx4 v[120:123], v1, s[44:47], s8 offen offset:2048 nt
s_waitcnt vmcnt(5)
buffer_load_dwordx4 v[124:127], v1, s[44:47], s8 offen offset:3072 nt
s_add_u32 s8, s8, 16384
s_waitcnt vmcnt(5)
buffer_load_dwordx4 v[128:131], v1, s[44:47], s8 offen offset:0 nt
v_permlane32_swap_b32 v56, v58
v_permlane32_swap_b32 v57, v59
v_permlane32_swap_b32 v60, v62
v_permlane32_swap_b32 v61, v63
v_permlane32_swap_b32 v64, v66
v_permlane32_swap_b32 v65, v67
v_permlane32_swap_b32 v68, v70
v_permlane32_swap_b32 v69, v71
v_add_f32 v56, v56, v58
v_add_f32 v57, v57, v59
v_add_f32 v60, v60, v62
v_add_f32 v61, v61, v63
v_add_f32 v64, v64, v66
v_add_f32 v65, v65, v67
v_add_f32 v68, v68, v70
v_add_f32 v69, v69, v71
v_permlane16_swap_b32 v56, v57
v_permlane16_swap_b32 v60, v61
v_permlane16_swap_b32 v64, v65
v_permlane16_swap_b32 v68, v69
v_add_f32 v56, v56, v57
v_add_f32 v60, v60, v61
v_add_f32 v64, v64, v65
v_add_f32 v68, v68, v69
v_add_f32_dpp v57, v56, v56 row_ror:4 row_mask:0xf bank_mask:0xf
v_add_f32_dpp v61, v60, v60 row_ror:4 row_mask:0xf bank_mask:0xf
v_add_f32_dpp v65, v64, v64 row_ror:4 row_mask:0xf bank_mask:0xf
v_add_f32_dpp v69, v68, v68 row_ror:4 row_mask:0xf bank_mask:0xf
v_add_f32_dpp v56, v57, v57 row_ror:8 row_mask:0xf bank_mask:0xf
v_add_f32_dpp v60, v61, v61 row_ror:8 row_mask:0xf bank_mask:0xf
v_add_f32_dpp v64, v65, v65 row_ror:8 row_mask:0xf bank_mask:0xf
v_add_f32_dpp v68, v69, v69 row_ror:8 row_mask:0xf bank_mask:0xf
v_cvt_pk_bf16_f32 v5, v56, v60
v_cvt_pk_bf16_f32 v6, v64, v68
v_lshlrev_b32 v7, 16, v5
v_and_b32 v8, s12, v5
v_lshlrev_b32 v9, 16, v6
v_and_b32 v10, s12, v6
v_mul_f32 v7, s13, v7
v_mul_f32 v8, s13, v8
v_mul_f32 v9, s13, v9
v_mul_f32 v10, s13, v10
v_cvt_pk_bf16_f32 v28, v7, v8
v_cvt_pk_bf16_f32 v29, v9, v10
v_max3_f32 v3, v3, v7, v8
v_max3_f32 v3, v3, v9, v10
s_waitcnt vmcnt(33)
v_mfma_f32_4x4x4_16b_bf16 v[56:59], v[144:145], v[20:21], 0
v_mfma_f32_4x4x4_16b_bf16 v[60:63], v[148:149], v[20:21], 0
v_mfma_f32_4x4x4_16b_bf16 v[64:67], v[152:153], v[20:21], 0
v_mfma_f32_4x4x4_16b_bf16 v[68:71], v[156:157], v[20:21], 0
v_mfma_f32_4x4x4_16b_bf16 v[56:59], v[146:147], v[22:23], v[56:59]
v_mfma_f32_4x4x4_16b_bf16 v[60:63], v[150:151], v[22:23], v[60:63]
v_mfma_f32_4x4x4_16b_bf16 v[64:67], v[154:155], v[22:23], v[64:67]
v_mfma_f32_4x4x4_16b_bf16 v[68:71], v[158:159], v[22:23], v[68:71]
s_waitcnt vmcnt(5)
buffer_load_dwordx4 v[132:135], v1, s[44:47], s8 offen offset:1024 nt
s_waitcnt vmcnt(5)
buffer_load_dwordx4 v[136:139], v1, s[44:47], s8 offen offset:2048 nt
s_waitcnt vmcnt(5)
buffer_load_dwordx4 v[140:143], v1, s[44:47], s8 offen offset:3072 nt
s_add_u32 s8, s8, 16384
v_permlane32_swap_b32 v56, v58
v_permlane32_swap_b32 v57, v59
v_permlane32_swap_b32 v60, v62
v_permlane32_swap_b32 v61, v63
v_permlane32_swap_b32 v64, v66
v_permlane32_swap_b32 v65, v67
v_permlane32_swap_b32 v68, v70
v_permlane32_swap_b32 v69, v71
v_add_f32 v56, v56, v58
v_add_f32 v57, v57, v59
v_add_f32 v60, v60, v62
v_add_f32 v61, v61, v63
v_add_f32 v64, v64, v66
v_add_f32 v65, v65, v67
v_add_f32 v68, v68, v70
v_add_f32 v69, v69, v71
v_permlane16_swap_b32 v56, v57
v_permlane16_swap_b32 v60, v61
v_permlane16_swap_b32 v64, v65
v_permlane16_swap_b32 v68, v69
v_add_f32 v56, v56, v57
v_add_f32 v60, v60, v61
v_add_f32 v64, v64, v65
v_add_f32 v68, v68, v69
v_add_f32_dpp v57, v56, v56 row_ror:4 row_mask:0xf bank_mask:0xf
v_add_f32_dpp v61, v60, v60 row_ror:4 row_mask:0xf bank_mask:0xf
v_add_f32_dpp v65, v64, v64 row_ror:4 row_mask:0xf bank_mask:0xf
v_add_f32_dpp v69, v68, v68 row_ror:4 row_mask:0xf bank_mask:0xf
v_add_f32_dpp v56, v57, v57 row_ror:8 row_mask:0xf bank_mask:0xf
v_add_f32_dpp v60, v61, v61 row_ror:8 row_mask:0xf bank_mask:0xf
v_add_f32_dpp v64, v65, v65 row_ror:8 row_mask:0xf bank_mask:0xf
v_add_f32_dpp v68, v69, v69 row_ror:8 row_mask:0xf bank_mask:0xf
v_cvt_pk_bf16_f32 v5, v56, v60
v_cvt_pk_bf16_f32 v6, v64, v68
v_lshlrev_b32 v7, 16, v5
v_and_b32 v8, s12, v5
v_lshlrev_b32 v9, 16, v6
v_and_b32 v10, s12, v6
v_mul_f32 v7, s13, v7
v_mul_f32 v8, s13, v8
v_mul_f32 v9, s13, v9
v_mul_f32 v10, s13, v10
v_cvt_pk_bf16_f32 v30, v7, v8
v_cvt_pk_bf16_f32 v31, v9, v10
v_max3_f32 v3, v3, v7, v8
v_max3_f32 v3, v3, v9, v10
L_pad5:
s_cbranch_execz L_pad6
s_waitcnt vmcnt(32)
v_mfma_f32_4x4x4_16b_bf16 v[56:59], v[160:161], v[20:21], 0
v_mfma_f32_4x4x4_16b_bf16 v[60:63], v[164:165], v[20:21], 0
v_mfma_f32_4x4x4_16b_bf16 v[64:67], v[168:169], v[20:21], 0
v_mfma_f32_4x4x4_16b_bf16 v[68:71], v[172:173], v[20:21], 0
v_mfma_f32_4x4x4_16b_bf16 v[56:59], v[162:163], v[22:23], v[56:59]
v_mfma_f32_4x4x4_16b_bf16 v[60:63], v[166:167], v[22:23], v[60:63]
v_mfma_f32_4x4x4_16b_bf16 v[64:67], v[170:171], v[22:23], v[64:67]
v_mfma_f32_4x4x4_16b_bf16 v[68:71], v[174:175], v[22:23], v[68:71]
s_waitcnt vmcnt(5)
buffer_load_dwordx4 v[144:147], v1, s[44:47], s8 offen offset:0 nt
s_waitcnt vmcnt(5)
buffer_load_dwordx4 v[148:151], v1, s[44:47], s8 offen offset:1024 nt
s_waitcnt vmcnt(5)
buffer_load_dwordx4 v[152:155], v1, s[44:47], s8 offen offset:2048 nt
v_permlane32_swap_b32 v56, v58
v_permlane32_swap_b32 v57, v59
v_permlane32_swap_b32 v60, v62
v_permlane32_swap_b32 v61, v63
v_permlane32_swap_b32 v64, v66
v_permlane32_swap_b32 v65, v67
v_permlane32_swap_b32 v68, v70
v_permlane32_swap_b32 v69, v71
v_add_f32 v56, v56, v58
v_add_f32 v57, v57, v59
v_add_f32 v60, v60, v62
v_add_f32 v61, v61, v63
v_add_f32 v64, v64, v66
v_add_f32 v65, v65, v67
v_add_f32 v68, v68, v70
v_add_f32 v69, v69, v71
v_permlane16_swap_b32 v56, v57
v_permlane16_swap_b32 v60, v61
v_permlane16_swap_b32 v64, v65
v_permlane16_swap_b32 v68, v69
v_add_f32 v56, v56, v57
v_add_f32 v60, v60, v61
v_add_f32 v64, v64, v65
v_add_f32 v68, v68, v69
v_add_f32_dpp v57, v56, v56 row_ror:4 row_mask:0xf bank_mask:0xf
v_add_f32_dpp v61, v60, v60 row_ror:4 row_mask:0xf bank_mask:0xf
v_add_f32_dpp v65, v64, v64 row_ror:4 row_mask:0xf bank_mask:0xf
v_add_f32_dpp v69, v68, v68 row_ror:4 row_mask:0xf bank_mask:0xf
v_add_f32_dpp v56, v57, v57 row_ror:8 row_mask:0xf bank_mask:0xf
v_add_f32_dpp v60, v61, v61 row_ror:8 row_mask:0xf bank_mask:0xf
v_add_f32_dpp v64, v65, v65 row_ror:8 row_mask:0xf bank_mask:0xf
v_add_f32_dpp v68, v69, v69 row_ror:8 row_mask:0xf bank_mask:0xf
v_cvt_pk_bf16_f32 v5, v56, v60
v_cvt_pk_bf16_f32 v6, v64, v68
v_lshlrev_b32 v7, 16, v5
v_and_b32 v8, s12, v5
v_lshlrev_b32 v9, 16, v6
v_and_b32 v10, s12, v6
v_mul_f32 v7, s13, v7
v_mul_f32 v8, s13, v8
v_mul_f32 v9, s13, v9
v_mul_f32 v10, s13, v10
v_cvt_pk_bf16_f32 v32, v7, v8
v_cvt_pk_bf16_f32 v33, v9, v10
v_max3_f32 v3, v3, v7, v8
v_max3_f32 v3, v3, v9, v10
s_waitcnt vmcnt(31)
v_mfma_f32_4x4x4_16b_bf16 v[56:59], v[176:177], v[20:21], 0
v_mfma_f32_4x4x4_16b_bf16 v[60:63], v[180:181], v[20:21], 0
v_mfma_f32_4x4x4_16b_bf16 v[64:67], v[184:185], v[20:21], 0
v_mfma_f32_4x4x4_16b_bf16 v[68:71], v[188:189], v[20:21], 0
v_mfma_f32_4x4x4_16b_bf16 v[56:59], v[178:179], v[22:23], v[56:59]
v_mfma_f32_4x4x4_16b_bf16 v[60:63], v[182:183], v[22:23], v[60:63]
v_mfma_f32_4x4x4_16b_bf16 v[64:67], v[186:187], v[22:23], v[64:67]
v_mfma_f32_4x4x4_16b_bf16 v[68:71], v[190:191], v[22:23], v[68:71]
s_waitcnt vmcnt(5)
buffer_load_dwordx4 v[156:159], v1, s[44:47], s8 offen offset:3072 nt
s_add_u32 s8, s8, 16384
s_waitcnt vmcnt(5)
buffer_load_dwordx4 v[160:163], v1, s[44:47], s8 offen offset:0 nt
s_waitcnt vmcnt(5)
buffer_load_dwordx4 v[164:167], v1, s[44:47], s8 offen offset:1024 nt
v_permlane32_swap_b32 v56, v58
v_permlane32_swap_b32 v57, v59
v_permlane32_swap_b32 v60, v62
v_permlane32_swap_b32 v61, v63
v_permlane32_swap_b32 v64, v66
v_permlane32_swap_b32 v65, v67
v_permlane32_swap_b32 v68, v70
v_permlane32_swap_b32 v69, v71
v_add_f32 v56, v56, v58
v_add_f32 v57, v57, v59
v_add_f32 v60, v60, v62
v_add_f32 v61, v61, v63
v_add_f32 v64, v64, v66
v_add_f32 v65, v65, v67
v_add_f32 v68, v68, v70
v_add_f32 v69, v69, v71
v_permlane16_swap_b32 v56, v57
v_permlane16_swap_b32 v60, v61
v_permlane16_swap_b32 v64, v65
v_permlane16_swap_b32 v68, v69
v_add_f32 v56, v56, v57
v_add_f32 v60, v60, v61
v_add_f32 v64, v64, v65
v_add_f32 v68, v68, v69
v_add_f32_dpp v57, v56, v56 row_ror:4 row_mask:0xf bank_mask:0xf
v_add_f32_dpp v61, v60, v60 row_ror:4 row_mask:0xf bank_mask:0xf
v_add_f32_dpp v65, v64, v64 row_ror:4 row_mask:0xf bank_mask:0xf
v_add_f32_dpp v69, v68, v68 row_ror:4 row_mask:0xf bank_mask:0xf
v_add_f32_dpp v56, v57, v57 row_ror:8 row_mask:0xf bank_mask:0xf
v_add_f32_dpp v60, v61, v61 row_ror:8 row_mask:0xf bank_mask:0xf
v_add_f32_dpp v64, v65, v65 row_ror:8 row_mask:0xf bank_mask:0xf
v_add_f32_dpp v68, v69, v69 row_ror:8 row_mask:0xf bank_mask:0xf
v_cvt_pk_bf16_f32 v5, v56, v60
v_cvt_pk_bf16_f32 v6, v64, v68
v_lshlrev_b32 v7, 16, v5
v_and_b32 v8, s12, v5
v_lshlrev_b32 v9, 16, v6
v_and_b32 v10, s12, v6
v_mul_f32 v7, s13, v7
v_mul_f32 v8, s13, v8
v_mul_f32 v9, s13, v9
v_mul_f32 v10, s13, v10
v_cvt_pk_bf16_f32 v34, v7, v8
v_cvt_pk_bf16_f32 v35, v9, v10
v_max3_f32 v3, v3, v7, v8
v_max3_f32 v3, v3, v9, v10
L_pad6:
s_cbranch_execz L_pad7
s_waitcnt vmcnt(30)
v_mfma_f32_4x4x4_16b_bf16 v[56:59], v[192:193], v[20:21], 0
v_mfma_f32_4x4x4_16b_bf16 v[60:63], v[196:197], v[20:21], 0
v_mfma_f32_4x4x4_16b_bf16 v[64:67], v[200:201], v[20:21], 0
v_mfma_f32_4x4x4_16b_bf16 v[68:71], v[204:205], v[20:21], 0
v_mfma_f32_4x4x4_16b_bf16 v[56:59], v[194:195], v[22:23], v[56:59]
v_mfma_f32_4x4x4_16b_bf16 v[60:63], v[198:199], v[22:23], v[60:63]
v_mfma_f32_4x4x4_16b_bf16 v[64:67], v[202:203], v[22:23], v[64:67]
v_mfma_f32_4x4x4_16b_bf16 v[68:71], v[206:207], v[22:23], v[68:71]
s_waitcnt vmcnt(5)
buffer_load_dwordx4 v[168:171], v1, s[44:47], s8 offen offset:2048 nt
s_waitcnt vmcnt(5)
buffer_load_dwordx4 v[172:175], v1, s[44:47], s8 offen offset:3072 nt
s_add_u32 s8, s8, 16384
s_waitcnt vmcnt(5)
buffer_load_dwordx4 v[176:179], v1, s[44:47], s8 offen offset:0 nt
v_permlane32_swap_b32 v56, v58
v_permlane32_swap_b32 v57, v59
v_permlane32_swap_b32 v60, v62
v_permlane32_swap_b32 v61, v63
v_permlane32_swap_b32 v64, v66
v_permlane32_swap_b32 v65, v67
v_permlane32_swap_b32 v68, v70
v_permlane32_swap_b32 v69, v71
v_add_f32 v56, v56, v58
v_add_f32 v57, v57, v59
v_add_f32 v60, v60, v62
v_add_f32 v61, v61, v63
v_add_f32 v64, v64, v66
v_add_f32 v65, v65, v67
v_add_f32 v68, v68, v70
v_add_f32 v69, v69, v71
v_permlane16_swap_b32 v56, v57
v_permlane16_swap_b32 v60, v61
v_permlane16_swap_b32 v64, v65
v_permlane16_swap_b32 v68, v69
v_add_f32 v56, v56, v57
v_add_f32 v60, v60, v61
v_add_f32 v64, v64, v65
v_add_f32 v68, v68, v69
v_add_f32_dpp v57, v56, v56 row_ror:4 row_mask:0xf bank_mask:0xf
v_add_f32_dpp v61, v60, v60 row_ror:4 row_mask:0xf bank_mask:0xf
v_add_f32_dpp v65, v64, v64 row_ror:4 row_mask:0xf bank_mask:0xf
v_add_f32_dpp v69, v68, v68 row_ror:4 row_mask:0xf bank_mask:0xf
v_add_f32_dpp v56, v57, v57 row_ror:8 row_mask:0xf bank_mask:0xf
v_add_f32_dpp v60, v61, v61 row_ror:8 row_mask:0xf bank_mask:0xf
v_add_f32_dpp v64, v65, v65 row_ror:8 row_mask:0xf bank_mask:0xf
v_add_f32_dpp v68, v69, v69 row_ror:8 row_mask:0xf bank_mask:0xf
v_cvt_pk_bf16_f32 v5, v56, v60
v_cvt_pk_bf16_f32 v6, v64, v68
v_lshlrev_b32 v7, 16, v5
v_and_b32 v8, s12, v5
v_lshlrev_b32 v9, 16, v6
v_and_b32 v10, s12, v6
v_mul_f32 v7, s13, v7
v_mul_f32 v8, s13, v8
v_mul_f32 v9, s13, v9
v_mul_f32 v10, s13, v10
v_cvt_pk_bf16_f32 v36, v7, v8
v_cvt_pk_bf16_f32 v37, v9, v10
v_max3_f32 v3, v3, v7, v8
v_max3_f32 v3, v3, v9, v10
s_waitcnt vmcnt(29)
v_mfma_f32_4x4x4_16b_bf16 v[56:59], v[208:209], v[20:21], 0
v_mfma_f32_4x4x4_16b_bf16 v[60:63], v[212:213], v[20:21], 0
v_mfma_f32_4x4x4_16b_bf16 v[64:67], v[216:217], v[20:21], 0
v_mfma_f32_4x4x4_16b_bf16 v[68:71], v[220:221], v[20:21], 0
v_mfma_f32_4x4x4_16b_bf16 v[56:59], v[210:211], v[22:23], v[56:59]
v_mfma_f32_4x4x4_16b_bf16 v[60:63], v[214:215], v[22:23], v[60:63]
v_mfma_f32_4x4x4_16b_bf16 v[64:67], v[218:219], v[22:23], v[64:67]
v_mfma_f32_4x4x4_16b_bf16 v[68:71], v[222:223], v[22:23], v[68:71]
s_waitcnt vmcnt(5)
buffer_load_dwordx4 v[180:183], v1, s[44:47], s8 offen offset:1024 nt
s_waitcnt vmcnt(5)
buffer_load_dwordx4 v[184:187], v1, s[44:47], s8 offen offset:2048 nt
s_waitcnt vmcnt(5)
buffer_load_dwordx4 v[188:191], v1, s[44:47], s8 offen offset:3072 nt
v_permlane32_swap_b32 v56, v58
v_permlane32_swap_b32 v57, v59
v_permlane32_swap_b32 v60, v62
v_permlane32_swap_b32 v61, v63
v_permlane32_swap_b32 v64, v66
v_permlane32_swap_b32 v65, v67
v_permlane32_swap_b32 v68, v70
v_permlane32_swap_b32 v69, v71
v_add_f32 v56, v56, v58
v_add_f32 v57, v57, v59
v_add_f32 v60, v60, v62
v_add_f32 v61, v61, v63
v_add_f32 v64, v64, v66
v_add_f32 v65, v65, v67
v_add_f32 v68, v68, v70
v_add_f32 v69, v69, v71
v_permlane16_swap_b32 v56, v57
v_permlane16_swap_b32 v60, v61
v_permlane16_swap_b32 v64, v65
v_permlane16_swap_b32 v68, v69
v_add_f32 v56, v56, v57
v_add_f32 v60, v60, v61
v_add_f32 v64, v64, v65
v_add_f32 v68, v68, v69
v_add_f32_dpp v57, v56, v56 row_ror:4 row_mask:0xf bank_mask:0xf
v_add_f32_dpp v61, v60, v60 row_ror:4 row_mask:0xf bank_mask:0xf
v_add_f32_dpp v65, v64, v64 row_ror:4 row_mask:0xf bank_mask:0xf
v_add_f32_dpp v69, v68, v68 row_ror:4 row_mask:0xf bank_mask:0xf
v_add_f32_dpp v56, v57, v57 row_ror:8 row_mask:0xf bank_mask:0xf
v_add_f32_dpp v60, v61, v61 row_ror:8 row_mask:0xf bank_mask:0xf
v_add_f32_dpp v64, v65, v65 row_ror:8 row_mask:0xf bank_mask:0xf
v_add_f32_dpp v68, v69, v69 row_ror:8 row_mask:0xf bank_mask:0xf
v_cvt_pk_bf16_f32 v5, v56, v60
v_cvt_pk_bf16_f32 v6, v64, v68
v_lshlrev_b32 v7, 16, v5
v_and_b32 v8, s12, v5
v_lshlrev_b32 v9, 16, v6
v_and_b32 v10, s12, v6
v_mul_f32 v7, s13, v7
v_mul_f32 v8, s13, v8
v_mul_f32 v9, s13, v9
v_mul_f32 v10, s13, v10
v_cvt_pk_bf16_f32 v38, v7, v8
v_cvt_pk_bf16_f32 v39, v9, v10
v_max3_f32 v3, v3, v7, v8
v_max3_f32 v3, v3, v9, v10
s_waitcnt vmcnt(28)
v_mfma_f32_4x4x4_16b_bf16 v[56:59], v[224:225], v[20:21], 0
v_mfma_f32_4x4x4_16b_bf16 v[60:63], v[228:229], v[20:21], 0
v_mfma_f32_4x4x4_16b_bf16 v[64:67], v[232:233], v[20:21], 0
v_mfma_f32_4x4x4_16b_bf16 v[68:71], v[236:237], v[20:21], 0
v_mfma_f32_4x4x4_16b_bf16 v[56:59], v[226:227], v[22:23], v[56:59]
v_mfma_f32_4x4x4_16b_bf16 v[60:63], v[230:231], v[22:23], v[60:63]
v_mfma_f32_4x4x4_16b_bf16 v[64:67], v[234:235], v[22:23], v[64:67]
v_mfma_f32_4x4x4_16b_bf16 v[68:71], v[238:239], v[22:23], v[68:71]
s_waitcnt vmcnt(5)
s_mov_b32 s8, s7
buffer_load_dwordx4 v[192:195], v2, s[48:51], s8 offen offset:0 nt
s_waitcnt vmcnt(5)
buffer_load_dwordx4 v[196:199], v2, s[48:51], s8 offen offset:1024 nt
s_waitcnt vmcnt(5)
buffer_load_dwordx4 v[200:203], v2, s[48:51], s8 offen offset:2048 nt
v_permlane32_swap_b32 v56, v58
v_permlane32_swap_b32 v57, v59
v_permlane32_swap_b32 v60, v62
v_permlane32_swap_b32 v61, v63
v_permlane32_swap_b32 v64, v66
v_permlane32_swap_b32 v65, v67
v_permlane32_swap_b32 v68, v70
v_permlane32_swap_b32 v69, v71
v_add_f32 v56, v56, v58
v_add_f32 v57, v57, v59
v_add_f32 v60, v60, v62
v_add_f32 v61, v61, v63
v_add_f32 v64, v64, v66
v_add_f32 v65, v65, v67
v_add_f32 v68, v68, v70
v_add_f32 v69, v69, v71
v_permlane16_swap_b32 v56, v57
v_permlane16_swap_b32 v60, v61
v_permlane16_swap_b32 v64, v65
v_permlane16_swap_b32 v68, v69
v_add_f32 v56, v56, v57
v_add_f32 v60, v60, v61
v_add_f32 v64, v64, v65
v_add_f32 v68, v68, v69
L_pad7:
s_cbranch_execz L_pad8
v_add_f32_dpp v57, v56, v56 row_ror:4 row_mask:0xf bank_mask:0xf
v_add_f32_dpp v61, v60, v60 row_ror:4 row_mask:0xf bank_mask:0xf
v_add_f32_dpp v65, v64, v64 row_ror:4 row_mask:0xf bank_mask:0xf
v_add_f32_dpp v69, v68, v68 row_ror:4 row_mask:0xf bank_mask:0xf
v_add_f32_dpp v56, v57, v57 row_ror:8 row_mask:0xf bank_mask:0xf
v_add_f32_dpp v60, v61, v61 row_ror:8 row_mask:0xf bank_mask:0xf
v_add_f32_dpp v64, v65, v65 row_ror:8 row_mask:0xf bank_mask:0xf
v_add_f32_dpp v68, v69, v69 row_ror:8 row_mask:0xf bank_mask:0xf
v_cvt_pk_bf16_f32 v5, v56, v60
v_cvt_pk_bf16_f32 v6, v64, v68
v_lshlrev_b32 v7, 16, v5
v_and_b32 v8, s12, v5
v_lshlrev_b32 v9, 16, v6
v_and_b32 v10, s12, v6
v_mul_f32 v7, s13, v7
v_mul_f32 v8, s13, v8
v_mul_f32 v9, s13, v9
v_mul_f32 v10, s13, v10
v_cvt_pk_bf16_f32 v40, v7, v8
v_cvt_pk_bf16_f32 v41, v9, v10
v_max3_f32 v3, v3, v7, v8
v_max3_f32 v3, v3, v9, v10
s_waitcnt vmcnt(27)
v_mfma_f32_4x4x4_16b_bf16 v[56:59], v[240:241], v[20:21], 0
v_mfma_f32_4x4x4_16b_bf16 v[60:63], v[244:245], v[20:21], 0
v_mfma_f32_4x4x4_16b_bf16 v[64:67], v[248:249], v[20:21], 0
v_mfma_f32_4x4x4_16b_bf16 v[68:71], v[252:253], v[20:21], 0
v_mfma_f32_4x4x4_16b_bf16 v[56:59], v[242:243], v[22:23], v[56:59]
v_mfma_f32_4x4x4_16b_bf16 v[60:63], v[246:247], v[22:23], v[60:63]
v_mfma_f32_4x4x4_16b_bf16 v[64:67], v[250:251], v[22:23], v[64:67]
v_mfma_f32_4x4x4_16b_bf16 v[68:71], v[254:255], v[22:23], v[68:71]
s_waitcnt vmcnt(5)
buffer_load_dwordx4 v[204:207], v2, s[48:51], s8 offen offset:3072 nt
s_add_u32 s8, s8, 16384
s_waitcnt vmcnt(5)
buffer_load_dwordx4 v[208:211], v2, s[48:51], s8 offen offset:0 nt
s_waitcnt vmcnt(5)
buffer_load_dwordx4 v[212:215], v2, s[48:51], s8 offen offset:1024 nt
v_permlane32_swap_b32 v56, v58
v_permlane32_swap_b32 v57, v59
v_permlane32_swap_b32 v60, v62
v_permlane32_swap_b32 v61, v63
v_permlane32_swap_b32 v64, v66
v_permlane32_swap_b32 v65, v67
v_permlane32_swap_b32 v68, v70
v_permlane32_swap_b32 v69, v71
v_add_f32 v56, v56, v58
v_add_f32 v57, v57, v59
v_add_f32 v60, v60, v62
v_add_f32 v61, v61, v63
v_add_f32 v64, v64, v66
v_add_f32 v65, v65, v67
v_add_f32 v68, v68, v70
v_add_f32 v69, v69, v71
v_permlane16_swap_b32 v56, v57
v_permlane16_swap_b32 v60, v61
v_permlane16_swap_b32 v64, v65
v_permlane16_swap_b32 v68, v69
v_add_f32 v56, v56, v57
v_add_f32 v60, v60, v61
v_add_f32 v64, v64, v65
v_add_f32 v68, v68, v69
v_add_f32_dpp v57, v56, v56 row_ror:4 row_mask:0xf bank_mask:0xf
v_add_f32_dpp v61, v60, v60 row_ror:4 row_mask:0xf bank_mask:0xf
v_add_f32_dpp v65, v64, v64 row_ror:4 row_mask:0xf bank_mask:0xf
v_add_f32_dpp v69, v68, v68 row_ror:4 row_mask:0xf bank_mask:0xf
v_add_f32_dpp v56, v57, v57 row_ror:8 row_mask:0xf bank_mask:0xf
v_add_f32_dpp v60, v61, v61 row_ror:8 row_mask:0xf bank_mask:0xf
v_add_f32_dpp v64, v65, v65 row_ror:8 row_mask:0xf bank_mask:0xf
v_add_f32_dpp v68, v69, v69 row_ror:8 row_mask:0xf bank_mask:0xf
v_cvt_pk_bf16_f32 v5, v56, v60
v_cvt_pk_bf16_f32 v6, v64, v68
v_lshlrev_b32 v7, 16, v5
v_and_b32 v8, s12, v5
v_lshlrev_b32 v9, 16, v6
v_and_b32 v10, s12, v6
v_mul_f32 v7, s13, v7
v_mul_f32 v8, s13, v8
v_mul_f32 v9, s13, v9
v_mul_f32 v10, s13, v10
v_cvt_pk_bf16_f32 v42, v7, v8
v_cvt_pk_bf16_f32 v43, v9, v10
v_max3_f32 v3, v3, v7, v8
v_max3_f32 v3, v3, v9, v10
s_waitcnt vmcnt(26)
v_mfma_f32_4x4x4_16b_bf16 v[56:59], v[96:97], v[20:21], 0
v_mfma_f32_4x4x4_16b_bf16 v[60:63], v[100:101], v[20:21], 0
v_mfma_f32_4x4x4_16b_bf16 v[64:67], v[104:105], v[20:21], 0
v_mfma_f32_4x4x4_16b_bf16 v[68:71], v[108:109], v[20:21], 0
v_mfma_f32_4x4x4_16b_bf16 v[56:59], v[98:99], v[22:23], v[56:59]
v_mfma_f32_4x4x4_16b_bf16 v[60:63], v[102:103], v[22:23], v[60:63]
v_mfma_f32_4x4x4_16b_bf16 v[64:67], v[106:107], v[22:23], v[64:67]
v_mfma_f32_4x4x4_16b_bf16 v[68:71], v[110:111], v[22:23], v[68:71]
s_waitcnt vmcnt(5)
buffer_load_dwordx4 v[216:219], v2, s[48:51], s8 offen offset:2048 nt
s_waitcnt vmcnt(5)
buffer_load_dwordx4 v[220:223], v2, s[48:51], s8 offen offset:3072 nt
s_add_u32 s8, s8, 16384
s_waitcnt vmcnt(5)
buffer_load_dwordx4 v[224:227], v2, s[48:51], s8 offen offset:0 nt
v_permlane32_swap_b32 v56, v58
v_permlane32_swap_b32 v57, v59
v_permlane32_swap_b32 v60, v62
v_permlane32_swap_b32 v61, v63
v_permlane32_swap_b32 v64, v66
v_permlane32_swap_b32 v65, v67
v_permlane32_swap_b32 v68, v70
v_permlane32_swap_b32 v69, v71
v_add_f32 v56, v56, v58
v_add_f32 v57, v57, v59
v_add_f32 v60, v60, v62
v_add_f32 v61, v61, v63
v_add_f32 v64, v64, v66
v_add_f32 v65, v65, v67
v_add_f32 v68, v68, v70
v_add_f32 v69, v69, v71
v_permlane16_swap_b32 v56, v57
v_permlane16_swap_b32 v60, v61
v_permlane16_swap_b32 v64, v65
v_permlane16_swap_b32 v68, v69
v_add_f32 v56, v56, v57
v_add_f32 v60, v60, v61
v_add_f32 v64, v64, v65
v_add_f32 v68, v68, v69
v_add_f32_dpp v57, v56, v56 row_ror:4 row_mask:0xf bank_mask:0xf
v_add_f32_dpp v61, v60, v60 row_ror:4 row_mask:0xf bank_mask:0xf
v_add_f32_dpp v65, v64, v64 row_ror:4 row_mask:0xf bank_mask:0xf
v_add_f32_dpp v69, v68, v68 row_ror:4 row_mask:0xf bank_mask:0xf
v_add_f32_dpp v56, v57, v57 row_ror:8 row_mask:0xf bank_mask:0xf
v_add_f32_dpp v60, v61, v61 row_ror:8 row_mask:0xf bank_mask:0xf
v_add_f32_dpp v64, v65, v65 row_ror:8 row_mask:0xf bank_mask:0xf
v_add_f32_dpp v68, v69, v69 row_ror:8 row_mask:0xf bank_mask:0xf
v_cvt_pk_bf16_f32 v5, v56, v60
v_cvt_pk_bf16_f32 v6, v64, v68
v_lshlrev_b32 v7, 16, v5
v_and_b32 v8, s12, v5
v_lshlrev_b32 v9, 16, v6
v_and_b32 v10, s12, v6
v_mul_f32 v7, s13, v7
v_mul_f32 v8, s13, v8
v_mul_f32 v9, s13, v9
v_mul_f32 v10, s13, v10
v_cvt_pk_bf16_f32 v44, v7, v8
v_cvt_pk_bf16_f32 v45, v9, v10
v_max3_f32 v3, v3, v7, v8
v_max3_f32 v3, v3, v9, v10
L_pad8:
s_cbranch_execz L_pad9
s_waitcnt vmcnt(25)
v_mfma_f32_4x4x4_16b_bf16 v[56:59], v[112:113], v[20:21], 0
v_mfma_f32_4x4x4_16b_bf16 v[60:63], v[116:117], v[20:21], 0
v_mfma_f32_4x4x4_16b_bf16 v[64:67], v[120:121], v[20:21], 0
v_mfma_f32_4x4x4_16b_bf16 v[68:71], v[124:125], v[20:21], 0
v_mfma_f32_4x4x4_16b_bf16 v[56:59], v[114:115], v[22:23], v[56:59]
v_mfma_f32_4x4x4_16b_bf16 v[60:63], v[118:119], v[22:23], v[60:63]
v_mfma_f32_4x4x4_16b_bf16 v[64:67], v[122:123], v[22:23], v[64:67]
v_mfma_f32_4x4x4_16b_bf16 v[68:71], v[126:127], v[22:23], v[68:71]
s_waitcnt vmcnt(5)
buffer_load_dwordx4 v[228:231], v2, s[48:51], s8 offen offset:1024 nt
s_waitcnt vmcnt(5)
buffer_load_dwordx4 v[232:235], v2, s[48:51], s8 offen offset:2048 nt
s_waitcnt vmcnt(5)
buffer_load_dwordx4 v[236:239], v2, s[48:51], s8 offen offset:3072 nt
s_add_u32 s8, s8, 16384
v_permlane32_swap_b32 v56, v58
v_permlane32_swap_b32 v57, v59
v_permlane32_swap_b32 v60, v62
v_permlane32_swap_b32 v61, v63
v_permlane32_swap_b32 v64, v66
v_permlane32_swap_b32 v65, v67
v_permlane32_swap_b32 v68, v70
v_permlane32_swap_b32 v69, v71
v_add_f32 v56, v56, v58
v_add_f32 v57, v57, v59
v_add_f32 v60, v60, v62
v_add_f32 v61, v61, v63
v_add_f32 v64, v64, v66
v_add_f32 v65, v65, v67
v_add_f32 v68, v68, v70
v_add_f32 v69, v69, v71
v_permlane16_swap_b32 v56, v57
v_permlane16_swap_b32 v60, v61
v_permlane16_swap_b32 v64, v65
v_permlane16_swap_b32 v68, v69
v_add_f32 v56, v56, v57
v_add_f32 v60, v60, v61
v_add_f32 v64, v64, v65
v_add_f32 v68, v68, v69
v_add_f32_dpp v57, v56, v56 row_ror:4 row_mask:0xf bank_mask:0xf
v_add_f32_dpp v61, v60, v60 row_ror:4 row_mask:0xf bank_mask:0xf
v_add_f32_dpp v65, v64, v64 row_ror:4 row_mask:0xf bank_mask:0xf
v_add_f32_dpp v69, v68, v68 row_ror:4 row_mask:0xf bank_mask:0xf
v_add_f32_dpp v56, v57, v57 row_ror:8 row_mask:0xf bank_mask:0xf
v_add_f32_dpp v60, v61, v61 row_ror:8 row_mask:0xf bank_mask:0xf
v_add_f32_dpp v64, v65, v65 row_ror:8 row_mask:0xf bank_mask:0xf
v_add_f32_dpp v68, v69, v69 row_ror:8 row_mask:0xf bank_mask:0xf
v_cvt_pk_bf16_f32 v5, v56, v60
v_cvt_pk_bf16_f32 v6, v64, v68
v_lshlrev_b32 v7, 16, v5
v_and_b32 v8, s12, v5
v_lshlrev_b32 v9, 16, v6
v_and_b32 v10, s12, v6
v_mul_f32 v7, s13, v7
v_mul_f32 v8, s13, v8
v_mul_f32 v9, s13, v9
v_mul_f32 v10, s13, v10
v_cvt_pk_bf16_f32 v46, v7, v8
v_cvt_pk_bf16_f32 v47, v9, v10
v_max3_f32 v3, v3, v7, v8
v_max3_f32 v3, v3, v9, v10
s_waitcnt vmcnt(24)
v_mfma_f32_4x4x4_16b_bf16 v[56:59], v[128:129], v[20:21], 0
v_mfma_f32_4x4x4_16b_bf16 v[60:63], v[132:133], v[20:21], 0
v_mfma_f32_4x4x4_16b_bf16 v[64:67], v[136:137], v[20:21], 0
v_mfma_f32_4x4x4_16b_bf16 v[68:71], v[140:141], v[20:21], 0
v_mfma_f32_4x4x4_16b_bf16 v[56:59], v[130:131], v[22:23], v[56:59]
v_mfma_f32_4x4x4_16b_bf16 v[60:63], v[134:135], v[22:23], v[60:63]
v_mfma_f32_4x4x4_16b_bf16 v[64:67], v[138:139], v[22:23], v[64:67]
v_mfma_f32_4x4x4_16b_bf16 v[68:71], v[142:143], v[22:23], v[68:71]
s_waitcnt vmcnt(5)
buffer_load_dwordx4 v[240:243], v2, s[48:51], s8 offen offset:0 nt
s_waitcnt vmcnt(5)
buffer_load_dwordx4 v[244:247], v2, s[48:51], s8 offen offset:1024 nt
s_waitcnt vmcnt(5)
buffer_load_dwordx4 v[248:251], v2, s[48:51], s8 offen offset:2048 nt
v_permlane32_swap_b32 v56, v58
v_permlane32_swap_b32 v57, v59
v_permlane32_swap_b32 v60, v62
v_permlane32_swap_b32 v61, v63
v_permlane32_swap_b32 v64, v66
v_permlane32_swap_b32 v65, v67
v_permlane32_swap_b32 v68, v70
v_permlane32_swap_b32 v69, v71
v_add_f32 v56, v56, v58
v_add_f32 v57, v57, v59
v_add_f32 v60, v60, v62
v_add_f32 v61, v61, v63
v_add_f32 v64, v64, v66
v_add_f32 v65, v65, v67
v_add_f32 v68, v68, v70
v_add_f32 v69, v69, v71
v_permlane16_swap_b32 v56, v57
v_permlane16_swap_b32 v60, v61
v_permlane16_swap_b32 v64, v65
v_permlane16_swap_b32 v68, v69
v_add_f32 v56, v56, v57
v_add_f32 v60, v60, v61
v_add_f32 v64, v64, v65
v_add_f32 v68, v68, v69
v_add_f32_dpp v57, v56, v56 row_ror:4 row_mask:0xf bank_mask:0xf
v_add_f32_dpp v61, v60, v60 row_ror:4 row_mask:0xf bank_mask:0xf
v_add_f32_dpp v65, v64, v64 row_ror:4 row_mask:0xf bank_mask:0xf
v_add_f32_dpp v69, v68, v68 row_ror:4 row_mask:0xf bank_mask:0xf
v_add_f32_dpp v56, v57, v57 row_ror:8 row_mask:0xf bank_mask:0xf
v_add_f32_dpp v60, v61, v61 row_ror:8 row_mask:0xf bank_mask:0xf
v_add_f32_dpp v64, v65, v65 row_ror:8 row_mask:0xf bank_mask:0xf
v_add_f32_dpp v68, v69, v69 row_ror:8 row_mask:0xf bank_mask:0xf
v_cvt_pk_bf16_f32 v5, v56, v60
v_cvt_pk_bf16_f32 v6, v64, v68
v_lshlrev_b32 v7, 16, v5
v_and_b32 v8, s12, v5
v_lshlrev_b32 v9, 16, v6
v_and_b32 v10, s12, v6
v_mul_f32 v7, s13, v7
v_mul_f32 v8, s13, v8
v_mul_f32 v9, s13, v9
v_mul_f32 v10, s13, v10
v_cvt_pk_bf16_f32 v48, v7, v8
v_cvt_pk_bf16_f32 v49, v9, v10
v_max3_f32 v3, v3, v7, v8
v_max3_f32 v3, v3, v9, v10
L_pad9:
s_cbranch_execz L_pad10
s_waitcnt vmcnt(23)
v_mfma_f32_4x4x4_16b_bf16 v[56:59], v[144:145], v[20:21], 0
v_mfma_f32_4x4x4_16b_bf16 v[60:63], v[148:149], v[20:21], 0
v_mfma_f32_4x4x4_16b_bf16 v[64:67], v[152:153], v[20:21], 0
v_mfma_f32_4x4x4_16b_bf16 v[68:71], v[156:157], v[20:21], 0
v_mfma_f32_4x4x4_16b_bf16 v[56:59], v[146:147], v[22:23], v[56:59]
v_mfma_f32_4x4x4_16b_bf16 v[60:63], v[150:151], v[22:23], v[60:63]
v_mfma_f32_4x4x4_16b_bf16 v[64:67], v[154:155], v[22:23], v[64:67]
v_mfma_f32_4x4x4_16b_bf16 v[68:71], v[158:159], v[22:23], v[68:71]
s_waitcnt vmcnt(5)
buffer_load_dwordx4 v[252:255], v2, s[48:51], s8 offen offset:3072 nt
s_add_u32 s8, s8, 16384
s_waitcnt vmcnt(5)
buffer_load_dwordx4 v[128:131], v2, s[48:51], s8 offen offset:0 nt
s_waitcnt vmcnt(5)
buffer_load_dwordx4 v[132:135], v2, s[48:51], s8 offen offset:1024 nt
v_permlane32_swap_b32 v56, v58
v_permlane32_swap_b32 v57, v59
v_permlane32_swap_b32 v60, v62
v_permlane32_swap_b32 v61, v63
v_permlane32_swap_b32 v64, v66
v_permlane32_swap_b32 v65, v67
v_permlane32_swap_b32 v68, v70
v_permlane32_swap_b32 v69, v71
v_add_f32 v56, v56, v58
v_add_f32 v57, v57, v59
v_add_f32 v60, v60, v62
v_add_f32 v61, v61, v63
v_add_f32 v64, v64, v66
v_add_f32 v65, v65, v67
v_add_f32 v68, v68, v70
v_add_f32 v69, v69, v71
v_permlane16_swap_b32 v56, v57
v_permlane16_swap_b32 v60, v61
v_permlane16_swap_b32 v64, v65
v_permlane16_swap_b32 v68, v69
v_add_f32 v56, v56, v57
v_add_f32 v60, v60, v61
v_add_f32 v64, v64, v65
v_add_f32 v68, v68, v69
v_add_f32_dpp v57, v56, v56 row_ror:4 row_mask:0xf bank_mask:0xf
v_add_f32_dpp v61, v60, v60 row_ror:4 row_mask:0xf bank_mask:0xf
v_add_f32_dpp v65, v64, v64 row_ror:4 row_mask:0xf bank_mask:0xf
v_add_f32_dpp v69, v68, v68 row_ror:4 row_mask:0xf bank_mask:0xf
v_add_f32_dpp v56, v57, v57 row_ror:8 row_mask:0xf bank_mask:0xf
v_add_f32_dpp v60, v61, v61 row_ror:8 row_mask:0xf bank_mask:0xf
v_add_f32_dpp v64, v65, v65 row_ror:8 row_mask:0xf bank_mask:0xf
v_add_f32_dpp v68, v69, v69 row_ror:8 row_mask:0xf bank_mask:0xf
v_cvt_pk_bf16_f32 v5, v56, v60
v_cvt_pk_bf16_f32 v6, v64, v68
v_lshlrev_b32 v7, 16, v5
v_and_b32 v8, s12, v5
v_lshlrev_b32 v9, 16, v6
v_and_b32 v10, s12, v6
v_mul_f32 v7, s13, v7
v_mul_f32 v8, s13, v8
v_mul_f32 v9, s13, v9
v_mul_f32 v10, s13, v10
v_cvt_pk_bf16_f32 v50, v7, v8
v_cvt_pk_bf16_f32 v51, v9, v10
v_max3_f32 v3, v3, v7, v8
v_max3_f32 v3, v3, v9, v10
s_waitcnt vmcnt(22)
v_mfma_f32_4x4x4_16b_bf16 v[56:59], v[160:161], v[20:21], 0
v_mfma_f32_4x4x4_16b_bf16 v[60:63], v[164:165], v[20:21], 0
v_mfma_f32_4x4x4_16b_bf16 v[64:67], v[168:169], v[20:21], 0
v_mfma_f32_4x4x4_16b_bf16 v[68:71], v[172:173], v[20:21], 0
v_mfma_f32_4x4x4_16b_bf16 v[56:59], v[162:163], v[22:23], v[56:59]
v_mfma_f32_4x4x4_16b_bf16 v[60:63], v[166:167], v[22:23], v[60:63]
v_mfma_f32_4x4x4_16b_bf16 v[64:67], v[170:171], v[22:23], v[64:67]
v_mfma_f32_4x4x4_16b_bf16 v[68:71], v[174:175], v[22:23], v[68:71]
s_waitcnt vmcnt(5)
buffer_load_dwordx4 v[136:139], v2, s[48:51], s8 offen offset:2048 nt
s_waitcnt vmcnt(5)
buffer_load_dwordx4 v[140:143], v2, s[48:51], s8 offen offset:3072 nt
s_add_u32 s8, s8, 16384
s_waitcnt vmcnt(5)
buffer_load_dwordx4 v[144:147], v2, s[48:51], s8 offen offset:0 nt
v_permlane32_swap_b32 v56, v58
v_permlane32_swap_b32 v57, v59
v_permlane32_swap_b32 v60, v62
v_permlane32_swap_b32 v61, v63
v_permlane32_swap_b32 v64, v66
v_permlane32_swap_b32 v65, v67
v_permlane32_swap_b32 v68, v70
v_permlane32_swap_b32 v69, v71
v_add_f32 v56, v56, v58
v_add_f32 v57, v57, v59
v_add_f32 v60, v60, v62
v_add_f32 v61, v61, v63
v_add_f32 v64, v64, v66
v_add_f32 v65, v65, v67
v_add_f32 v68, v68, v70
v_add_f32 v69, v69, v71
v_permlane16_swap_b32 v56, v57
v_permlane16_swap_b32 v60, v61
v_permlane16_swap_b32 v64, v65
v_permlane16_swap_b32 v68, v69
v_add_f32 v56, v56, v57
v_add_f32 v60, v60, v61
v_add_f32 v64, v64, v65
v_add_f32 v68, v68, v69
v_add_f32_dpp v57, v56, v56 row_ror:4 row_mask:0xf bank_mask:0xf
v_add_f32_dpp v61, v60, v60 row_ror:4 row_mask:0xf bank_mask:0xf
v_add_f32_dpp v65, v64, v64 row_ror:4 row_mask:0xf bank_mask:0xf
v_add_f32_dpp v69, v68, v68 row_ror:4 row_mask:0xf bank_mask:0xf
v_add_f32_dpp v56, v57, v57 row_ror:8 row_mask:0xf bank_mask:0xf
v_add_f32_dpp v60, v61, v61 row_ror:8 row_mask:0xf bank_mask:0xf
v_add_f32_dpp v64, v65, v65 row_ror:8 row_mask:0xf bank_mask:0xf
v_add_f32_dpp v68, v69, v69 row_ror:8 row_mask:0xf bank_mask:0xf
v_cvt_pk_bf16_f32 v5, v56, v60
v_cvt_pk_bf16_f32 v6, v64, v68
v_lshlrev_b32 v7, 16, v5
v_and_b32 v8, s12, v5
v_lshlrev_b32 v9, 16, v6
v_and_b32 v10, s12, v6
v_mul_f32 v7, s13, v7
v_mul_f32 v8, s13, v8
v_mul_f32 v9, s13, v9
v_mul_f32 v10, s13, v10
v_cvt_pk_bf16_f32 v52, v7, v8
v_cvt_pk_bf16_f32 v53, v9, v10
v_max3_f32 v3, v3, v7, v8
v_max3_f32 v3, v3, v9, v10
L_pad10:
s_cbranch_execz L_pad11
s_waitcnt vmcnt(21)
v_mfma_f32_4x4x4_16b_bf16 v[56:59], v[176:177], v[20:21], 0
v_mfma_f32_4x4x4_16b_bf16 v[60:63], v[180:181], v[20:21], 0
v_mfma_f32_4x4x4_16b_bf16 v[64:67], v[184:185], v[20:21], 0
v_mfma_f32_4x4x4_16b_bf16 v[68:71], v[188:189], v[20:21], 0
v_mfma_f32_4x4x4_16b_bf16 v[56:59], v[178:179], v[22:23], v[56:59]
v_mfma_f32_4x4x4_16b_bf16 v[60:63], v[182:183], v[22:23], v[60:63]
v_mfma_f32_4x4x4_16b_bf16 v[64:67], v[186:187], v[22:23], v[64:67]
v_mfma_f32_4x4x4_16b_bf16 v[68:71], v[190:191], v[22:23], v[68:71]
s_waitcnt vmcnt(5)
buffer_load_dwordx4 v[148:151], v2, s[48:51], s8 offen offset:1024 nt
s_waitcnt vmcnt(5)
buffer_load_dwordx4 v[152:155], v2, s[48:51], s8 offen offset:2048 nt
s_waitcnt vmcnt(5)
buffer_load_dwordx4 v[156:159], v2, s[48:51], s8 offen offset:3072 nt
s_add_u32 s8, s8, 16384
buffer_load_dwordx4 v[160:163], v2, s[48:51], s8 offen offset:0 nt
buffer_load_dwordx4 v[164:167], v2, s[48:51], s8 offen offset:1024 nt
v_permlane32_swap_b32 v56, v58
v_permlane32_swap_b32 v57, v59
v_permlane32_swap_b32 v60, v62
v_permlane32_swap_b32 v61, v63
v_permlane32_swap_b32 v64, v66
v_permlane32_swap_b32 v65, v67
v_permlane32_swap_b32 v68, v70
v_permlane32_swap_b32 v69, v71
v_add_f32 v56, v56, v58
v_add_f32 v57, v57, v59
v_add_f32 v60, v60, v62
v_add_f32 v61, v61, v63
v_add_f32 v64, v64, v66
v_add_f32 v65, v65, v67
v_add_f32 v68, v68, v70
v_add_f32 v69, v69, v71
v_permlane16_swap_b32 v56, v57
v_permlane16_swap_b32 v60, v61
v_permlane16_swap_b32 v64, v65
v_permlane16_swap_b32 v68, v69
v_add_f32 v56, v56, v57
v_add_f32 v60, v60, v61
v_add_f32 v64, v64, v65
v_add_f32 v68, v68, v69
v_add_f32_dpp v57, v56, v56 row_ror:4 row_mask:0xf bank_mask:0xf
v_add_f32_dpp v61, v60, v60 row_ror:4 row_mask:0xf bank_mask:0xf
v_add_f32_dpp v65, v64, v64 row_ror:4 row_mask:0xf bank_mask:0xf
v_add_f32_dpp v69, v68, v68 row_ror:4 row_mask:0xf bank_mask:0xf
v_add_f32_dpp v56, v57, v57 row_ror:8 row_mask:0xf bank_mask:0xf
v_add_f32_dpp v60, v61, v61 row_ror:8 row_mask:0xf bank_mask:0xf
v_add_f32_dpp v64, v65, v65 row_ror:8 row_mask:0xf bank_mask:0xf
v_add_f32_dpp v68, v69, v69 row_ror:8 row_mask:0xf bank_mask:0xf
v_cvt_pk_bf16_f32 v5, v56, v60
v_cvt_pk_bf16_f32 v6, v64, v68
v_lshlrev_b32 v7, 16, v5
v_and_b32 v8, s12, v5
v_lshlrev_b32 v9, 16, v6
v_and_b32 v10, s12, v6
v_mul_f32 v7, s13, v7
v_mul_f32 v8, s13, v8
v_mul_f32 v9, s13, v9
v_mul_f32 v10, s13, v10
v_cvt_pk_bf16_f32 v54, v7, v8
v_cvt_pk_bf16_f32 v55, v9, v10
v_max3_f32 v3, v3, v7, v8
v_max3_f32 v3, v3, v9, v10
v_mov_b32 v5, v3
s_nop 1
v_permlane16_swap_b32 v5, v3
v_max_f32 v3, v3, v5
v_mov_b32 v5, v3
s_nop 1
v_permlane32_swap_b32 v5, v3
v_max_f32 v3, v3, v5
v_and_b32 v5, 3, v0
v_lshlrev_b32 v5, 4, v5
s_lshl_b32 s9, s6, 2
v_add_u32 v6, s9, v5
s_mov_b64 exec, 15
ds_write_b32 v6, v3 offset:35840
s_mov_b64 exec, -1
s_waitcnt lgkmcnt(0)
s_barrier
ds_read_b128 v[8:11], v5 offset:35840
s_mov_b32 s14, 1069066811
v_mov_b32 v4, 0
s_waitcnt lgkmcnt(0)
v_max3_f32 v3, v8, v9, v10
v_max_f32 v3, v3, v11
v_cvt_pk_bf16_f32 v3, v3, v3
v_lshlrev_b32 v3, 16, v3
v_mul_f32 v3, s14, v3
v_lshlrev_b32 v7, 16, v24
v_and_b32 v8, s12, v24
v_lshlrev_b32 v9, 16, v25
v_and_b32 v10, s12, v25
v_fma_f32 v7, v7, s14, -v3
v_fma_f32 v8, v8, s14, -v3
v_fma_f32 v9, v9, s14, -v3
v_fma_f32 v10, v10, s14, -v3
v_exp_f32 v7, v7
v_exp_f32 v8, v8
v_exp_f32 v9, v9
v_exp_f32 v10, v10
v_cvt_pk_bf16_f32 v24, v7, v8
v_add_f32 v7, v7, v8
v_cvt_pk_bf16_f32 v25, v9, v10
v_add_f32 v9, v9, v10
v_add_f32 v4, v4, v7
v_add_f32 v4, v4, v9
v_lshlrev_b32 v7, 16, v26
v_and_b32 v8, s12, v26
v_lshlrev_b32 v9, 16, v27
v_and_b32 v10, s12, v27
v_fma_f32 v7, v7, s14, -v3
v_fma_f32 v8, v8, s14, -v3
v_fma_f32 v9, v9, s14, -v3
v_fma_f32 v10, v10, s14, -v3
v_exp_f32 v7, v7
v_exp_f32 v8, v8
v_exp_f32 v9, v9
v_exp_f32 v10, v10
v_cvt_pk_bf16_f32 v26, v7, v8
v_add_f32 v7, v7, v8
v_cvt_pk_bf16_f32 v27, v9, v10
v_add_f32 v9, v9, v10
v_add_f32 v4, v4, v7
v_add_f32 v4, v4, v9
v_mov_b32_dpp v24, v24 row_newbcast:3 row_mask:0xf bank_mask:8
v_mov_b32_dpp v25, v25 row_newbcast:3 row_mask:0xf bank_mask:8
v_mov_b32 v11, v11
v_mov_b32_dpp v24, v24 row_newbcast:2 row_mask:0xf bank_mask:4
v_mov_b32_dpp v25, v25 row_newbcast:2 row_mask:0xf bank_mask:4
v_mov_b32 v11, v11
v_mov_b32_dpp v24, v24 row_newbcast:1 row_mask:0xf bank_mask:2
v_mov_b32_dpp v25, v25 row_newbcast:1 row_mask:0xf bank_mask:2
v_mov_b32 v11, v11
v_mov_b32_dpp v24, v24 row_newbcast:0 row_mask:0xf bank_mask:1
v_mov_b32_dpp v25, v25 row_newbcast:0 row_mask:0xf bank_mask:1
L_pad11:
s_cbranch_execz L_pad12
s_waitcnt vmcnt(5)
buffer_load_dwordx4 v[168:171], v2, s[48:51], s8 offen offset:2048 nt
v_lshlrev_b32 v7, 16, v28
v_and_b32 v8, s12, v28
v_lshlrev_b32 v9, 16, v29
v_and_b32 v10, s12, v29
v_fma_f32 v7, v7, s14, -v3
v_fma_f32 v8, v8, s14, -v3
v_fma_f32 v9, v9, s14, -v3
v_fma_f32 v10, v10, s14, -v3
v_exp_f32 v7, v7
v_exp_f32 v8, v8
v_exp_f32 v9, v9
v_exp_f32 v10, v10
v_cvt_pk_bf16_f32 v28, v7, v8
v_add_f32 v7, v7, v8
v_cvt_pk_bf16_f32 v29, v9, v10
v_add_f32 v9, v9, v10
v_add_f32 v4, v4, v7
v_add_f32 v4, v4, v9
v_mov_b32_dpp v26, v26 row_newbcast:3 row_mask:0xf bank_mask:8
v_mov_b32_dpp v27, v27 row_newbcast:3 row_mask:0xf bank_mask:8
v_mov_b32 v11, v11
v_mov_b32_dpp v26, v26 row_newbcast:2 row_mask:0xf bank_mask:4
v_mov_b32_dpp v27, v27 row_newbcast:2 row_mask:0xf bank_mask:4
v_mov_b32 v11, v11
v_mov_b32_dpp v26, v26 row_newbcast:1 row_mask:0xf bank_mask:2
v_mov_b32_dpp v27, v27 row_newbcast:1 row_mask:0xf bank_mask:2
v_mov_b32 v11, v11
v_mov_b32_dpp v26, v26 row_newbcast:0 row_mask:0xf bank_mask:1
v_mov_b32_dpp v27, v27 row_newbcast:0 row_mask:0xf bank_mask:1
v_lshlrev_b32 v7, 16, v30
v_and_b32 v8, s12, v30
v_lshlrev_b32 v9, 16, v31
v_and_b32 v10, s12, v31
v_fma_f32 v7, v7, s14, -v3
v_fma_f32 v8, v8, s14, -v3
v_fma_f32 v9, v9, s14, -v3
v_fma_f32 v10, v10, s14, -v3
v_exp_f32 v7, v7
v_exp_f32 v8, v8
v_exp_f32 v9, v9
v_exp_f32 v10, v10
v_cvt_pk_bf16_f32 v30, v7, v8
v_add_f32 v7, v7, v8
v_cvt_pk_bf16_f32 v31, v9, v10
v_add_f32 v9, v9, v10
v_add_f32 v4, v4, v7
v_add_f32 v4, v4, v9
v_mov_b32_dpp v28, v28 row_newbcast:3 row_mask:0xf bank_mask:8
v_mov_b32_dpp v29, v29 row_newbcast:3 row_mask:0xf bank_mask:8
v_mov_b32 v11, v11
v_mov_b32_dpp v28, v28 row_newbcast:2 row_mask:0xf bank_mask:4
v_mov_b32_dpp v29, v29 row_newbcast:2 row_mask:0xf bank_mask:4
v_mov_b32 v11, v11
v_mov_b32_dpp v28, v28 row_newbcast:1 row_mask:0xf bank_mask:2
v_mov_b32_dpp v29, v29 row_newbcast:1 row_mask:0xf bank_mask:2
v_mov_b32 v11, v11
v_mov_b32_dpp v28, v28 row_newbcast:0 row_mask:0xf bank_mask:1
v_mov_b32_dpp v29, v29 row_newbcast:0 row_mask:0xf bank_mask:1
v_lshlrev_b32 v7, 16, v32
v_and_b32 v8, s12, v32
v_lshlrev_b32 v9, 16, v33
v_and_b32 v10, s12, v33
v_fma_f32 v7, v7, s14, -v3
v_fma_f32 v8, v8, s14, -v3
v_fma_f32 v9, v9, s14, -v3
v_fma_f32 v10, v10, s14, -v3
v_exp_f32 v7, v7
v_exp_f32 v8, v8
v_exp_f32 v9, v9
v_exp_f32 v10, v10
v_cvt_pk_bf16_f32 v32, v7, v8
v_add_f32 v7, v7, v8
v_cvt_pk_bf16_f32 v33, v9, v10
v_add_f32 v9, v9, v10
v_add_f32 v4, v4, v7
v_add_f32 v4, v4, v9
v_mov_b32_dpp v30, v30 row_newbcast:3 row_mask:0xf bank_mask:8
v_mov_b32_dpp v31, v31 row_newbcast:3 row_mask:0xf bank_mask:8
v_mov_b32 v11, v11
v_mov_b32_dpp v30, v30 row_newbcast:2 row_mask:0xf bank_mask:4
v_mov_b32_dpp v31, v31 row_newbcast:2 row_mask:0xf bank_mask:4
v_mov_b32 v11, v11
v_mov_b32_dpp v30, v30 row_newbcast:1 row_mask:0xf bank_mask:2
v_mov_b32_dpp v31, v31 row_newbcast:1 row_mask:0xf bank_mask:2
v_mov_b32 v11, v11
v_mov_b32_dpp v30, v30 row_newbcast:0 row_mask:0xf bank_mask:1
v_mov_b32_dpp v31, v31 row_newbcast:0 row_mask:0xf bank_mask:1
s_waitcnt vmcnt(5)
buffer_load_dwordx4 v[172:175], v2, s[48:51], s8 offen offset:3072 nt
s_add_u32 s8, s8, 16384
v_lshlrev_b32 v7, 16, v34
v_and_b32 v8, s12, v34
v_lshlrev_b32 v9, 16, v35
v_and_b32 v10, s12, v35
v_fma_f32 v7, v7, s14, -v3
v_fma_f32 v8, v8, s14, -v3
v_fma_f32 v9, v9, s14, -v3
v_fma_f32 v10, v10, s14, -v3
v_exp_f32 v7, v7
v_exp_f32 v8, v8
v_exp_f32 v9, v9
v_exp_f32 v10, v10
v_cvt_pk_bf16_f32 v34, v7, v8
v_add_f32 v7, v7, v8
v_cvt_pk_bf16_f32 v35, v9, v10
v_add_f32 v9, v9, v10
v_add_f32 v4, v4, v7
v_add_f32 v4, v4, v9
v_mov_b32_dpp v32, v32 row_newbcast:3 row_mask:0xf bank_mask:8
v_mov_b32_dpp v33, v33 row_newbcast:3 row_mask:0xf bank_mask:8
v_mov_b32 v11, v11
v_mov_b32_dpp v32, v32 row_newbcast:2 row_mask:0xf bank_mask:4
v_mov_b32_dpp v33, v33 row_newbcast:2 row_mask:0xf bank_mask:4
v_mov_b32 v11, v11
v_mov_b32_dpp v32, v32 row_newbcast:1 row_mask:0xf bank_mask:2
v_mov_b32_dpp v33, v33 row_newbcast:1 row_mask:0xf bank_mask:2
v_mov_b32 v11, v11
v_mov_b32_dpp v32, v32 row_newbcast:0 row_mask:0xf bank_mask:1
v_mov_b32_dpp v33, v33 row_newbcast:0 row_mask:0xf bank_mask:1
v_lshlrev_b32 v7, 16, v36
v_and_b32 v8, s12, v36
v_lshlrev_b32 v9, 16, v37
v_and_b32 v10, s12, v37
v_fma_f32 v7, v7, s14, -v3
v_fma_f32 v8, v8, s14, -v3
v_fma_f32 v9, v9, s14, -v3
v_fma_f32 v10, v10, s14, -v3
v_exp_f32 v7, v7
v_exp_f32 v8, v8
v_exp_f32 v9, v9
v_exp_f32 v10, v10
v_cvt_pk_bf16_f32 v36, v7, v8
v_add_f32 v7, v7, v8
v_cvt_pk_bf16_f32 v37, v9, v10
v_add_f32 v9, v9, v10
v_add_f32 v4, v4, v7
v_add_f32 v4, v4, v9
v_mov_b32_dpp v34, v34 row_newbcast:3 row_mask:0xf bank_mask:8
v_mov_b32_dpp v35, v35 row_newbcast:3 row_mask:0xf bank_mask:8
v_mov_b32 v11, v11
v_mov_b32_dpp v34, v34 row_newbcast:2 row_mask:0xf bank_mask:4
v_mov_b32_dpp v35, v35 row_newbcast:2 row_mask:0xf bank_mask:4
v_mov_b32 v11, v11
v_mov_b32_dpp v34, v34 row_newbcast:1 row_mask:0xf bank_mask:2
v_mov_b32_dpp v35, v35 row_newbcast:1 row_mask:0xf bank_mask:2
v_mov_b32 v11, v11
v_mov_b32_dpp v34, v34 row_newbcast:0 row_mask:0xf bank_mask:1
v_mov_b32_dpp v35, v35 row_newbcast:0 row_mask:0xf bank_mask:1
L_pad12:
s_cbranch_execz L_pad13
s_waitcnt vmcnt(5)
buffer_load_dwordx4 v[176:179], v2, s[48:51], s8 offen offset:0 nt
v_lshlrev_b32 v7, 16, v38
v_and_b32 v8, s12, v38
v_lshlrev_b32 v9, 16, v39
v_and_b32 v10, s12, v39
v_fma_f32 v7, v7, s14, -v3
v_fma_f32 v8, v8, s14, -v3
v_fma_f32 v9, v9, s14, -v3
v_fma_f32 v10, v10, s14, -v3
v_exp_f32 v7, v7
v_exp_f32 v8, v8
v_exp_f32 v9, v9
v_exp_f32 v10, v10
v_cvt_pk_bf16_f32 v38, v7, v8
v_add_f32 v7, v7, v8
v_cvt_pk_bf16_f32 v39, v9, v10
v_add_f32 v9, v9, v10
v_add_f32 v4, v4, v7
v_add_f32 v4, v4, v9
v_mov_b32_dpp v36, v36 row_newbcast:3 row_mask:0xf bank_mask:8
v_mov_b32_dpp v37, v37 row_newbcast:3 row_mask:0xf bank_mask:8
v_mov_b32 v11, v11
v_mov_b32_dpp v36, v36 row_newbcast:2 row_mask:0xf bank_mask:4
v_mov_b32_dpp v37, v37 row_newbcast:2 row_mask:0xf bank_mask:4
v_mov_b32 v11, v11
v_mov_b32_dpp v36, v36 row_newbcast:1 row_mask:0xf bank_mask:2
v_mov_b32_dpp v37, v37 row_newbcast:1 row_mask:0xf bank_mask:2
v_mov_b32 v11, v11
v_mov_b32_dpp v36, v36 row_newbcast:0 row_mask:0xf bank_mask:1
v_mov_b32_dpp v37, v37 row_newbcast:0 row_mask:0xf bank_mask:1
v_lshlrev_b32 v7, 16, v40
v_and_b32 v8, s12, v40
v_lshlrev_b32 v9, 16, v41
v_and_b32 v10, s12, v41
v_fma_f32 v7, v7, s14, -v3
v_fma_f32 v8, v8, s14, -v3
v_fma_f32 v9, v9, s14, -v3
v_fma_f32 v10, v10, s14, -v3
v_exp_f32 v7, v7
v_exp_f32 v8, v8
v_exp_f32 v9, v9
v_exp_f32 v10, v10
v_cvt_pk_bf16_f32 v40, v7, v8
v_add_f32 v7, v7, v8
v_cvt_pk_bf16_f32 v41, v9, v10
v_add_f32 v9, v9, v10
v_add_f32 v4, v4, v7
v_add_f32 v4, v4, v9
v_mov_b32_dpp v38, v38 row_newbcast:3 row_mask:0xf bank_mask:8
v_mov_b32_dpp v39, v39 row_newbcast:3 row_mask:0xf bank_mask:8
v_mov_b32 v11, v11
v_mov_b32_dpp v38, v38 row_newbcast:2 row_mask:0xf bank_mask:4
v_mov_b32_dpp v39, v39 row_newbcast:2 row_mask:0xf bank_mask:4
v_mov_b32 v11, v11
v_mov_b32_dpp v38, v38 row_newbcast:1 row_mask:0xf bank_mask:2
v_mov_b32_dpp v39, v39 row_newbcast:1 row_mask:0xf bank_mask:2
v_mov_b32 v11, v11
v_mov_b32_dpp v38, v38 row_newbcast:0 row_mask:0xf bank_mask:1
v_mov_b32_dpp v39, v39 row_newbcast:0 row_mask:0xf bank_mask:1
v_lshlrev_b32 v7, 16, v42
v_and_b32 v8, s12, v42
v_lshlrev_b32 v9, 16, v43
v_and_b32 v10, s12, v43
v_fma_f32 v7, v7, s14, -v3
v_fma_f32 v8, v8, s14, -v3
v_fma_f32 v9, v9, s14, -v3
v_fma_f32 v10, v10, s14, -v3
v_exp_f32 v7, v7
v_exp_f32 v8, v8
v_exp_f32 v9, v9
v_exp_f32 v10, v10
v_cvt_pk_bf16_f32 v42, v7, v8
v_add_f32 v7, v7, v8
v_cvt_pk_bf16_f32 v43, v9, v10
v_add_f32 v9, v9, v10
v_add_f32 v4, v4, v7
v_add_f32 v4, v4, v9
v_mov_b32_dpp v40, v40 row_newbcast:3 row_mask:0xf bank_mask:8
v_mov_b32_dpp v41, v41 row_newbcast:3 row_mask:0xf bank_mask:8
v_mov_b32 v11, v11
v_mov_b32_dpp v40, v40 row_newbcast:2 row_mask:0xf bank_mask:4
v_mov_b32_dpp v41, v41 row_newbcast:2 row_mask:0xf bank_mask:4
v_mov_b32 v11, v11
v_mov_b32_dpp v40, v40 row_newbcast:1 row_mask:0xf bank_mask:2
v_mov_b32_dpp v41, v41 row_newbcast:1 row_mask:0xf bank_mask:2
v_mov_b32 v11, v11
v_mov_b32_dpp v40, v40 row_newbcast:0 row_mask:0xf bank_mask:1
v_mov_b32_dpp v41, v41 row_newbcast:0 row_mask:0xf bank_mask:1
s_waitcnt vmcnt(5)
buffer_load_dwordx4 v[180:183], v2, s[48:51], s8 offen offset:1024 nt
v_lshlrev_b32 v7, 16, v44
v_and_b32 v8, s12, v44
v_lshlrev_b32 v9, 16, v45
v_and_b32 v10, s12, v45
v_fma_f32 v7, v7, s14, -v3
v_fma_f32 v8, v8, s14, -v3
v_fma_f32 v9, v9, s14, -v3
v_fma_f32 v10, v10, s14, -v3
v_exp_f32 v7, v7
v_exp_f32 v8, v8
v_exp_f32 v9, v9
v_exp_f32 v10, v10
v_cvt_pk_bf16_f32 v44, v7, v8
v_add_f32 v7, v7, v8
v_cvt_pk_bf16_f32 v45, v9, v10
v_add_f32 v9, v9, v10
v_add_f32 v4, v4, v7
v_add_f32 v4, v4, v9
v_mov_b32_dpp v42, v42 row_newbcast:3 row_mask:0xf bank_mask:8
v_mov_b32_dpp v43, v43 row_newbcast:3 row_mask:0xf bank_mask:8
v_mov_b32 v11, v11
v_mov_b32_dpp v42, v42 row_newbcast:2 row_mask:0xf bank_mask:4
v_mov_b32_dpp v43, v43 row_newbcast:2 row_mask:0xf bank_mask:4
v_mov_b32 v11, v11
v_mov_b32_dpp v42, v42 row_newbcast:1 row_mask:0xf bank_mask:2
v_mov_b32_dpp v43, v43 row_newbcast:1 row_mask:0xf bank_mask:2
v_mov_b32 v11, v11
v_mov_b32_dpp v42, v42 row_newbcast:0 row_mask:0xf bank_mask:1
v_mov_b32_dpp v43, v43 row_newbcast:0 row_mask:0xf bank_mask:1
v_lshlrev_b32 v7, 16, v46
v_and_b32 v8, s12, v46
v_lshlrev_b32 v9, 16, v47
v_and_b32 v10, s12, v47
v_fma_f32 v7, v7, s14, -v3
v_fma_f32 v8, v8, s14, -v3
v_fma_f32 v9, v9, s14, -v3
v_fma_f32 v10, v10, s14, -v3
v_exp_f32 v7, v7
v_exp_f32 v8, v8
v_exp_f32 v9, v9
v_exp_f32 v10, v10
v_cvt_pk_bf16_f32 v46, v7, v8
v_add_f32 v7, v7, v8
v_cvt_pk_bf16_f32 v47, v9, v10
v_add_f32 v9, v9, v10
v_add_f32 v4, v4, v7
v_add_f32 v4, v4, v9
v_mov_b32_dpp v44, v44 row_newbcast:3 row_mask:0xf bank_mask:8
v_mov_b32_dpp v45, v45 row_newbcast:3 row_mask:0xf bank_mask:8
v_mov_b32 v11, v11
v_mov_b32_dpp v44, v44 row_newbcast:2 row_mask:0xf bank_mask:4
v_mov_b32_dpp v45, v45 row_newbcast:2 row_mask:0xf bank_mask:4
v_mov_b32 v11, v11
v_mov_b32_dpp v44, v44 row_newbcast:1 row_mask:0xf bank_mask:2
v_mov_b32_dpp v45, v45 row_newbcast:1 row_mask:0xf bank_mask:2
v_mov_b32 v11, v11
v_mov_b32_dpp v44, v44 row_newbcast:0 row_mask:0xf bank_mask:1
v_mov_b32_dpp v45, v45 row_newbcast:0 row_mask:0xf bank_mask:1
L_pad13:
s_cbranch_execz L_pad14
v_lshlrev_b32 v7, 16, v48
v_and_b32 v8, s12, v48
v_lshlrev_b32 v9, 16, v49
v_and_b32 v10, s12, v49
v_fma_f32 v7, v7, s14, -v3
v_fma_f32 v8, v8, s14, -v3
v_fma_f32 v9, v9, s14, -v3
v_fma_f32 v10, v10, s14, -v3
v_exp_f32 v7, v7
v_exp_f32 v8, v8
v_exp_f32 v9, v9
v_exp_f32 v10, v10
v_cvt_pk_bf16_f32 v48, v7, v8
v_add_f32 v7, v7, v8
v_cvt_pk_bf16_f32 v49, v9, v10
v_add_f32 v9, v9, v10
v_add_f32 v4, v4, v7
v_add_f32 v4, v4, v9
v_mov_b32_dpp v46, v46 row_newbcast:3 row_mask:0xf bank_mask:8
v_mov_b32_dpp v47, v47 row_newbcast:3 row_mask:0xf bank_mask:8
v_mov_b32 v11, v11
v_mov_b32_dpp v46, v46 row_newbcast:2 row_mask:0xf bank_mask:4
v_mov_b32_dpp v47, v47 row_newbcast:2 row_mask:0xf bank_mask:4
v_mov_b32 v11, v11
v_mov_b32_dpp v46, v46 row_newbcast:1 row_mask:0xf bank_mask:2
v_mov_b32_dpp v47, v47 row_newbcast:1 row_mask:0xf bank_mask:2
v_mov_b32 v11, v11
v_mov_b32_dpp v46, v46 row_newbcast:0 row_mask:0xf bank_mask:1
v_mov_b32_dpp v47, v47 row_newbcast:0 row_mask:0xf bank_mask:1
s_waitcnt vmcnt(5)
buffer_load_dwordx4 v[184:187], v2, s[48:51], s8 offen offset:2048 nt
v_lshlrev_b32 v7, 16, v50
v_and_b32 v8, s12, v50
v_lshlrev_b32 v9, 16, v51
v_and_b32 v10, s12, v51
v_fma_f32 v7, v7, s14, -v3
v_fma_f32 v8, v8, s14, -v3
v_fma_f32 v9, v9, s14, -v3
v_fma_f32 v10, v10, s14, -v3
v_exp_f32 v7, v7
v_exp_f32 v8, v8
v_exp_f32 v9, v9
v_exp_f32 v10, v10
v_cvt_pk_bf16_f32 v50, v7, v8
v_add_f32 v7, v7, v8
v_cvt_pk_bf16_f32 v51, v9, v10
v_add_f32 v9, v9, v10
v_add_f32 v4, v4, v7
v_add_f32 v4, v4, v9
v_mov_b32_dpp v48, v48 row_newbcast:3 row_mask:0xf bank_mask:8
v_mov_b32_dpp v49, v49 row_newbcast:3 row_mask:0xf bank_mask:8
v_mov_b32 v11, v11
v_mov_b32_dpp v48, v48 row_newbcast:2 row_mask:0xf bank_mask:4
v_mov_b32_dpp v49, v49 row_newbcast:2 row_mask:0xf bank_mask:4
v_mov_b32 v11, v11
v_mov_b32_dpp v48, v48 row_newbcast:1 row_mask:0xf bank_mask:2
v_mov_b32_dpp v49, v49 row_newbcast:1 row_mask:0xf bank_mask:2
v_mov_b32 v11, v11
v_mov_b32_dpp v48, v48 row_newbcast:0 row_mask:0xf bank_mask:1
v_mov_b32_dpp v49, v49 row_newbcast:0 row_mask:0xf bank_mask:1
v_lshlrev_b32 v7, 16, v52
v_and_b32 v8, s12, v52
v_lshlrev_b32 v9, 16, v53
v_and_b32 v10, s12, v53
v_fma_f32 v7, v7, s14, -v3
v_fma_f32 v8, v8, s14, -v3
v_fma_f32 v9, v9, s14, -v3
v_fma_f32 v10, v10, s14, -v3
v_exp_f32 v7, v7
v_exp_f32 v8, v8
v_exp_f32 v9, v9
v_exp_f32 v10, v10
v_cvt_pk_bf16_f32 v52, v7, v8
v_add_f32 v7, v7, v8
v_cvt_pk_bf16_f32 v53, v9, v10
v_add_f32 v9, v9, v10
v_add_f32 v4, v4, v7
v_add_f32 v4, v4, v9
v_mov_b32_dpp v50, v50 row_newbcast:3 row_mask:0xf bank_mask:8
v_mov_b32_dpp v51, v51 row_newbcast:3 row_mask:0xf bank_mask:8
v_mov_b32 v11, v11
v_mov_b32_dpp v50, v50 row_newbcast:2 row_mask:0xf bank_mask:4
v_mov_b32_dpp v51, v51 row_newbcast:2 row_mask:0xf bank_mask:4
v_mov_b32 v11, v11
v_mov_b32_dpp v50, v50 row_newbcast:1 row_mask:0xf bank_mask:2
v_mov_b32_dpp v51, v51 row_newbcast:1 row_mask:0xf bank_mask:2
v_mov_b32 v11, v11
v_mov_b32_dpp v50, v50 row_newbcast:0 row_mask:0xf bank_mask:1
v_mov_b32_dpp v51, v51 row_newbcast:0 row_mask:0xf bank_mask:1
L_pad14:
s_cbranch_execz L_pad15
s_waitcnt vmcnt(5)
buffer_load_dwordx4 v[188:191], v2, s[48:51], s8 offen offset:3072 nt
s_add_u32 s8, s8, 16384
v_lshlrev_b32 v7, 16, v54
v_and_b32 v8, s12, v54
v_lshlrev_b32 v9, 16, v55
v_and_b32 v10, s12, v55
v_fma_f32 v7, v7, s14, -v3
v_fma_f32 v8, v8, s14, -v3
v_fma_f32 v9, v9, s14, -v3
v_fma_f32 v10, v10, s14, -v3
v_exp_f32 v7, v7
v_exp_f32 v8, v8
v_exp_f32 v9, v9
v_exp_f32 v10, v10
v_cvt_pk_bf16_f32 v54, v7, v8
v_add_f32 v7, v7, v8
v_cvt_pk_bf16_f32 v55, v9, v10
v_add_f32 v9, v9, v10
v_add_f32 v4, v4, v7
v_add_f32 v4, v4, v9
v_mov_b32_dpp v52, v52 row_newbcast:3 row_mask:0xf bank_mask:8
v_mov_b32_dpp v53, v53 row_newbcast:3 row_mask:0xf bank_mask:8
v_mov_b32 v11, v11
v_mov_b32_dpp v52, v52 row_newbcast:2 row_mask:0xf bank_mask:4
v_mov_b32_dpp v53, v53 row_newbcast:2 row_mask:0xf bank_mask:4
v_mov_b32 v11, v11
v_mov_b32_dpp v52, v52 row_newbcast:1 row_mask:0xf bank_mask:2
v_mov_b32_dpp v53, v53 row_newbcast:1 row_mask:0xf bank_mask:2
v_mov_b32 v11, v11
v_mov_b32_dpp v52, v52 row_newbcast:0 row_mask:0xf bank_mask:1
v_mov_b32_dpp v53, v53 row_newbcast:0 row_mask:0xf bank_mask:1
v_mov_b32_dpp v54, v54 row_newbcast:3 row_mask:0xf bank_mask:8
v_mov_b32_dpp v55, v55 row_newbcast:3 row_mask:0xf bank_mask:8
s_nop 0
v_mov_b32_dpp v54, v54 row_newbcast:2 row_mask:0xf bank_mask:4
v_mov_b32_dpp v55, v55 row_newbcast:2 row_mask:0xf bank_mask:4
s_nop 0
v_mov_b32_dpp v54, v54 row_newbcast:1 row_mask:0xf bank_mask:2
v_mov_b32_dpp v55, v55 row_newbcast:1 row_mask:0xf bank_mask:2
s_nop 0
v_mov_b32_dpp v54, v54 row_newbcast:0 row_mask:0xf bank_mask:1
v_mov_b32_dpp v55, v55 row_newbcast:0 row_mask:0xf bank_mask:1
v_mov_b32 v7, v4
s_nop 1
v_permlane16_swap_b32 v7, v4
v_add_f32 v4, v4, v7
v_mov_b32 v7, v4
s_nop 1
v_permlane32_swap_b32 v7, v4
v_add_f32 v4, v4, v7
s_mov_b64 exec, 15
ds_write_b32 v6, v4 offset:35904
s_mov_b64 exec, -1
s_waitcnt lgkmcnt(0)
s_barrier
s_lshl_b32 s9, s6, 4
v_mov_b32 v13, s9
ds_read_b128 v[8:11], v13 offset:35904
s_lshl_b32 s9, s6, 11
s_add_u32 s9, s9, 36864
v_lshl_add_u32 v15, v0, 2, s9
v_and_b32 v17, 3, v0
v_lshlrev_b32 v16, 9, v17
v_and_b32 v17, 60, v0
v_add_u32 v16, v16, v17
s_lshl_b32 s9, s6, 6
s_add_u32 s9, s9, 36864
v_add_u32 v16, s9, v16
v_lshlrev_b32 v17, 2, v0
s_lshl_b32 s15, s4, 15
s_lshl_b32 s10, s5, 8
s_add_u32 s15, s15, s10
s_lshl_b32 s10, s6, 13
s_add_u32 s15, s15, s10
s_add_u32 s15, s15, 262144
s_mov_b32 s16, 0x05040100
s_mov_b32 s17, 0x07060302
s_waitcnt lgkmcnt(0)
v_add_f32 v8, v8, v9
v_add_f32 v10, v10, v11
v_add_f32 v8, v8, v10
v_rcp_f32 v18, v8
s_waitcnt vmcnt(30)
v_perm_b32 v96, v196, v192, s16
v_perm_b32 v100, v196, v192, s17
v_perm_b32 v104, v197, v193, s16
v_perm_b32 v108, v197, v193, s17
v_perm_b32 v112, v198, v194, s16
v_perm_b32 v116, v198, v194, s17
v_perm_b32 v120, v199, v195, s16
v_perm_b32 v124, v199, v195, s17
s_waitcnt vmcnt(5)
buffer_load_dwordx4 v[192:195], v2, s[48:51], s8 offen offset:0 nt
s_waitcnt vmcnt(29)
v_perm_b32 v97, v204, v200, s16
v_perm_b32 v101, v204, v200, s17
v_perm_b32 v105, v205, v201, s16
v_perm_b32 v109, v205, v201, s17
v_perm_b32 v113, v206, v202, s16
v_perm_b32 v117, v206, v202, s17
v_perm_b32 v121, v207, v203, s16
v_perm_b32 v125, v207, v203, s17
s_waitcnt vmcnt(5)
buffer_load_dwordx4 v[196:199], v2, s[48:51], s8 offen offset:1024 nt
s_waitcnt vmcnt(28)
v_perm_b32 v98, v212, v208, s16
v_perm_b32 v102, v212, v208, s17
v_perm_b32 v106, v213, v209, s16
v_perm_b32 v110, v213, v209, s17
v_perm_b32 v114, v214, v210, s16
v_perm_b32 v118, v214, v210, s17
v_perm_b32 v122, v215, v211, s16
v_perm_b32 v126, v215, v211, s17
s_waitcnt vmcnt(5)
buffer_load_dwordx4 v[200:203], v2, s[48:51], s8 offen offset:2048 nt
s_waitcnt vmcnt(27)
v_perm_b32 v99, v220, v216, s16
v_perm_b32 v103, v220, v216, s17
v_perm_b32 v107, v221, v217, s16
v_perm_b32 v111, v221, v217, s17
v_perm_b32 v115, v222, v218, s16
v_perm_b32 v119, v222, v218, s17
v_perm_b32 v123, v223, v219, s16
v_perm_b32 v127, v223, v219, s17
s_waitcnt vmcnt(5)
buffer_load_dwordx4 v[204:207], v2, s[48:51], s8 offen offset:3072 nt
s_add_u32 s8, s8, 16384
v_mfma_f32_16x16x32_bf16 v[56:59], v[24:27], v[96:99], 0
v_mfma_f32_16x16x32_bf16 v[60:63], v[24:27], v[100:103], 0
v_mfma_f32_16x16x32_bf16 v[64:67], v[24:27], v[104:107], 0
v_mfma_f32_16x16x32_bf16 v[68:71], v[24:27], v[108:111], 0
v_mfma_f32_16x16x32_bf16 v[72:75], v[24:27], v[112:115], 0
v_mfma_f32_16x16x32_bf16 v[76:79], v[24:27], v[116:119], 0
v_mfma_f32_16x16x32_bf16 v[80:83], v[24:27], v[120:123], 0
v_mfma_f32_16x16x32_bf16 v[84:87], v[24:27], v[124:127], 0
L_pad15:
s_cbranch_execz L_pad16
s_waitcnt vmcnt(26)
v_perm_b32 v96, v228, v224, s16
v_perm_b32 v100, v228, v224, s17
v_perm_b32 v104, v229, v225, s16
v_perm_b32 v108, v229, v225, s17
v_perm_b32 v112, v230, v226, s16
v_perm_b32 v116, v230, v226, s17
v_perm_b32 v120, v231, v227, s16
v_perm_b32 v124, v231, v227, s17
s_waitcnt vmcnt(5)
buffer_load_dwordx4 v[208:211], v2, s[48:51], s8 offen offset:0 nt
s_waitcnt vmcnt(25)
v_perm_b32 v97, v236, v232, s16
v_perm_b32 v101, v236, v232, s17
v_perm_b32 v105, v237, v233, s16
v_perm_b32 v109, v237, v233, s17
v_perm_b32 v113, v238, v234, s16
v_perm_b32 v117, v238, v234, s17
v_perm_b32 v121, v239, v235, s16
v_perm_b32 v125, v239, v235, s17
s_waitcnt vmcnt(5)
buffer_load_dwordx4 v[212:215], v2, s[48:51], s8 offen offset:1024 nt
s_waitcnt vmcnt(24)
v_perm_b32 v98, v244, v240, s16
v_perm_b32 v102, v244, v240, s17
v_perm_b32 v106, v245, v241, s16
v_perm_b32 v110, v245, v241, s17
v_perm_b32 v114, v246, v242, s16
v_perm_b32 v118, v246, v242, s17
v_perm_b32 v122, v247, v243, s16
v_perm_b32 v126, v247, v243, s17
s_waitcnt vmcnt(5)
buffer_load_dwordx4 v[216:219], v2, s[48:51], s8 offen offset:2048 nt
s_waitcnt vmcnt(23)
v_perm_b32 v99, v252, v248, s16
v_perm_b32 v103, v252, v248, s17
v_perm_b32 v107, v253, v249, s16
v_perm_b32 v111, v253, v249, s17
v_perm_b32 v115, v254, v250, s16
v_perm_b32 v119, v254, v250, s17
v_perm_b32 v123, v255, v251, s16
v_perm_b32 v127, v255, v251, s17
s_waitcnt vmcnt(5)
buffer_load_dwordx4 v[220:223], v2, s[48:51], s8 offen offset:3072 nt
s_add_u32 s8, s8, 16384
v_mfma_f32_16x16x32_bf16 v[56:59], v[28:31], v[96:99], v[56:59]
v_mfma_f32_16x16x32_bf16 v[60:63], v[28:31], v[100:103], v[60:63]
v_mfma_f32_16x16x32_bf16 v[64:67], v[28:31], v[104:107], v[64:67]
v_mfma_f32_16x16x32_bf16 v[68:71], v[28:31], v[108:111], v[68:71]
v_mfma_f32_16x16x32_bf16 v[72:75], v[28:31], v[112:115], v[72:75]
v_mfma_f32_16x16x32_bf16 v[76:79], v[28:31], v[116:119], v[76:79]
v_mfma_f32_16x16x32_bf16 v[80:83], v[28:31], v[120:123], v[80:83]
v_mfma_f32_16x16x32_bf16 v[84:87], v[28:31], v[124:127], v[84:87]
s_waitcnt vmcnt(22)
v_perm_b32 v96, v132, v128, s16
v_perm_b32 v100, v132, v128, s17
v_perm_b32 v104, v133, v129, s16
v_perm_b32 v108, v133, v129, s17
v_perm_b32 v112, v134, v130, s16
v_perm_b32 v116, v134, v130, s17
v_perm_b32 v120, v135, v131, s16
v_perm_b32 v124, v135, v131, s17
s_waitcnt vmcnt(5)
buffer_load_dwordx4 v[224:227], v2, s[48:51], s8 offen offset:0 nt
s_waitcnt vmcnt(21)
v_perm_b32 v97, v140, v136, s16
v_perm_b32 v101, v140, v136, s17
v_perm_b32 v105, v141, v137, s16
v_perm_b32 v109, v141, v137, s17
v_perm_b32 v113, v142, v138, s16
v_perm_b32 v117, v142, v138, s17
v_perm_b32 v121, v143, v139, s16
v_perm_b32 v125, v143, v139, s17
s_waitcnt vmcnt(5)
buffer_load_dwordx4 v[228:231], v2, s[48:51], s8 offen offset:1024 nt
s_waitcnt vmcnt(20)
v_perm_b32 v98, v148, v144, s16
v_perm_b32 v102, v148, v144, s17
v_perm_b32 v106, v149, v145, s16
v_perm_b32 v110, v149, v145, s17
v_perm_b32 v114, v150, v146, s16
v_perm_b32 v118, v150, v146, s17
v_perm_b32 v122, v151, v147, s16
v_perm_b32 v126, v151, v147, s17
s_waitcnt vmcnt(5)
buffer_load_dwordx4 v[232:235], v2, s[48:51], s8 offen offset:2048 nt
s_waitcnt vmcnt(19)
v_perm_b32 v99, v156, v152, s16
v_perm_b32 v103, v156, v152, s17
v_perm_b32 v107, v157, v153, s16
v_perm_b32 v111, v157, v153, s17
v_perm_b32 v115, v158, v154, s16
v_perm_b32 v119, v158, v154, s17
v_perm_b32 v123, v159, v155, s16
v_perm_b32 v127, v159, v155, s17
s_waitcnt vmcnt(5)
buffer_load_dwordx4 v[236:239], v2, s[48:51], s8 offen offset:3072 nt
s_add_u32 s8, s8, 16384
v_mfma_f32_16x16x32_bf16 v[56:59], v[32:35], v[96:99], v[56:59]
v_mfma_f32_16x16x32_bf16 v[60:63], v[32:35], v[100:103], v[60:63]
v_mfma_f32_16x16x32_bf16 v[64:67], v[32:35], v[104:107], v[64:67]
v_mfma_f32_16x16x32_bf16 v[68:71], v[32:35], v[108:111], v[68:71]
v_mfma_f32_16x16x32_bf16 v[72:75], v[32:35], v[112:115], v[72:75]
v_mfma_f32_16x16x32_bf16 v[76:79], v[32:35], v[116:119], v[76:79]
v_mfma_f32_16x16x32_bf16 v[80:83], v[32:35], v[120:123], v[80:83]
v_mfma_f32_16x16x32_bf16 v[84:87], v[32:35], v[124:127], v[84:87]
s_waitcnt vmcnt(18)
v_perm_b32 v96, v164, v160, s16
v_perm_b32 v100, v164, v160, s17
v_perm_b32 v104, v165, v161, s16
v_perm_b32 v108, v165, v161, s17
v_perm_b32 v112, v166, v162, s16
v_perm_b32 v116, v166, v162, s17
v_perm_b32 v120, v167, v163, s16
v_perm_b32 v124, v167, v163, s17
L_pad16:
s_cbranch_execz L_pad17
s_waitcnt vmcnt(5)
buffer_load_dwordx4 v[240:243], v2, s[48:51], s8 offen offset:0 nt
s_waitcnt vmcnt(17)
v_perm_b32 v97, v172, v168, s16
v_perm_b32 v101, v172, v168, s17
v_perm_b32 v105, v173, v169, s16
v_perm_b32 v109, v173, v169, s17
v_perm_b32 v113, v174, v170, s16
v_perm_b32 v117, v174, v170, s17
v_perm_b32 v121, v175, v171, s16
v_perm_b32 v125, v175, v171, s17
s_waitcnt vmcnt(5)
buffer_load_dwordx4 v[244:247], v2, s[48:51], s8 offen offset:1024 nt
s_waitcnt vmcnt(16)
v_perm_b32 v98, v180, v176, s16
v_perm_b32 v102, v180, v176, s17
v_perm_b32 v106, v181, v177, s16
v_perm_b32 v110, v181, v177, s17
v_perm_b32 v114, v182, v178, s16
v_perm_b32 v118, v182, v178, s17
v_perm_b32 v122, v183, v179, s16
v_perm_b32 v126, v183, v179, s17
s_waitcnt vmcnt(5)
buffer_load_dwordx4 v[248:251], v2, s[48:51], s8 offen offset:2048 nt
s_waitcnt vmcnt(15)
v_perm_b32 v99, v188, v184, s16
v_perm_b32 v103, v188, v184, s17
v_perm_b32 v107, v189, v185, s16
v_perm_b32 v111, v189, v185, s17
v_perm_b32 v115, v190, v186, s16
v_perm_b32 v119, v190, v186, s17
v_perm_b32 v123, v191, v187, s16
v_perm_b32 v127, v191, v187, s17
s_waitcnt vmcnt(5)
buffer_load_dwordx4 v[252:255], v2, s[48:51], s8 offen offset:3072 nt
s_add_u32 s8, s8, 16384
v_mfma_f32_16x16x32_bf16 v[56:59], v[36:39], v[96:99], v[56:59]
v_mfma_f32_16x16x32_bf16 v[60:63], v[36:39], v[100:103], v[60:63]
v_mfma_f32_16x16x32_bf16 v[64:67], v[36:39], v[104:107], v[64:67]
v_mfma_f32_16x16x32_bf16 v[68:71], v[36:39], v[108:111], v[68:71]
v_mfma_f32_16x16x32_bf16 v[72:75], v[36:39], v[112:115], v[72:75]
v_mfma_f32_16x16x32_bf16 v[76:79], v[36:39], v[116:119], v[76:79]
v_mfma_f32_16x16x32_bf16 v[80:83], v[36:39], v[120:123], v[80:83]
v_mfma_f32_16x16x32_bf16 v[84:87], v[36:39], v[124:127], v[84:87]
s_waitcnt vmcnt(14)
v_perm_b32 v96, v196, v192, s16
v_perm_b32 v100, v196, v192, s17
v_perm_b32 v104, v197, v193, s16
v_perm_b32 v108, v197, v193, s17
v_perm_b32 v112, v198, v194, s16
v_perm_b32 v116, v198, v194, s17
v_perm_b32 v120, v199, v195, s16
v_perm_b32 v124, v199, v195, s17
s_waitcnt vmcnt(5)
buffer_load_dwordx4 v[128:131], v2, s[48:51], s8 offen offset:0 nt
s_waitcnt vmcnt(13)
v_perm_b32 v97, v204, v200, s16
v_perm_b32 v101, v204, v200, s17
v_perm_b32 v105, v205, v201, s16
v_perm_b32 v109, v205, v201, s17
v_perm_b32 v113, v206, v202, s16
v_perm_b32 v117, v206, v202, s17
v_perm_b32 v121, v207, v203, s16
v_perm_b32 v125, v207, v203, s17
s_waitcnt vmcnt(5)
buffer_load_dwordx4 v[132:135], v2, s[48:51], s8 offen offset:1024 nt
s_waitcnt vmcnt(12)
v_perm_b32 v98, v212, v208, s16
v_perm_b32 v102, v212, v208, s17
v_perm_b32 v106, v213, v209, s16
v_perm_b32 v110, v213, v209, s17
v_perm_b32 v114, v214, v210, s16
v_perm_b32 v118, v214, v210, s17
v_perm_b32 v122, v215, v211, s16
v_perm_b32 v126, v215, v211, s17
s_waitcnt vmcnt(5)
buffer_load_dwordx4 v[136:139], v2, s[48:51], s8 offen offset:2048 nt
s_waitcnt vmcnt(5)
buffer_load_dwordx4 v[140:143], v2, s[48:51], s8 offen offset:3072 nt
s_add_u32 s8, s8, 16384
s_waitcnt vmcnt(12)
v_perm_b32 v99, v220, v216, s16
v_perm_b32 v103, v220, v216, s17
v_perm_b32 v107, v221, v217, s16
v_perm_b32 v111, v221, v217, s17
v_perm_b32 v115, v222, v218, s16
v_perm_b32 v119, v222, v218, s17
v_perm_b32 v123, v223, v219, s16
v_perm_b32 v127, v223, v219, s17
s_waitcnt vmcnt(5)
buffer_load_dwordx4 v[144:147], v2, s[48:51], s8 offen offset:0 nt
s_waitcnt vmcnt(5)
buffer_load_dwordx4 v[148:151], v2, s[48:51], s8 offen offset:1024 nt
v_mfma_f32_16x16x32_bf16 v[56:59], v[40:43], v[96:99], v[56:59]
v_mfma_f32_16x16x32_bf16 v[60:63], v[40:43], v[100:103], v[60:63]
v_mfma_f32_16x16x32_bf16 v[64:67], v[40:43], v[104:107], v[64:67]
v_mfma_f32_16x16x32_bf16 v[68:71], v[40:43], v[108:111], v[68:71]
v_mfma_f32_16x16x32_bf16 v[72:75], v[40:43], v[112:115], v[72:75]
v_mfma_f32_16x16x32_bf16 v[76:79], v[40:43], v[116:119], v[76:79]
v_mfma_f32_16x16x32_bf16 v[80:83], v[40:43], v[120:123], v[80:83]
v_mfma_f32_16x16x32_bf16 v[84:87], v[40:43], v[124:127], v[84:87]
s_waitcnt vmcnt(12)
v_perm_b32 v96, v228, v224, s16
v_perm_b32 v100, v228, v224, s17
v_perm_b32 v104, v229, v225, s16
v_perm_b32 v108, v229, v225, s17
v_perm_b32 v112, v230, v226, s16
v_perm_b32 v116, v230, v226, s17
v_perm_b32 v120, v231, v227, s16
v_perm_b32 v124, v231, v227, s17
L_pad17:
s_cbranch_execz L_pad18
s_waitcnt vmcnt(5)
buffer_load_dwordx4 v[152:155], v2, s[48:51], s8 offen offset:2048 nt
s_waitcnt vmcnt(5)
buffer_load_dwordx4 v[156:159], v2, s[48:51], s8 offen offset:3072 nt
s_add_u32 s8, s8, 16384
s_waitcnt vmcnt(12)
v_perm_b32 v97, v236, v232, s16
v_perm_b32 v101, v236, v232, s17
v_perm_b32 v105, v237, v233, s16
v_perm_b32 v109, v237, v233, s17
v_perm_b32 v113, v238, v234, s16
v_perm_b32 v117, v238, v234, s17
v_perm_b32 v121, v239, v235, s16
v_perm_b32 v125, v239, v235, s17
s_waitcnt vmcnt(5)
buffer_load_dwordx4 v[160:163], v2, s[48:51], s8 offen offset:0 nt
s_waitcnt vmcnt(5)
buffer_load_dwordx4 v[164:167], v2, s[48:51], s8 offen offset:1024 nt
s_waitcnt vmcnt(12)
v_perm_b32 v98, v244, v240, s16
v_perm_b32 v102, v244, v240, s17
v_perm_b32 v106, v245, v241, s16
v_perm_b32 v110, v245, v241, s17
v_perm_b32 v114, v246, v242, s16
v_perm_b32 v118, v246, v242, s17
v_perm_b32 v122, v247, v243, s16
v_perm_b32 v126, v247, v243, s17
s_waitcnt vmcnt(5)
buffer_load_dwordx4 v[168:171], v2, s[48:51], s8 offen offset:2048 nt
s_waitcnt vmcnt(5)
buffer_load_dwordx4 v[172:175], v2, s[48:51], s8 offen offset:3072 nt
s_add_u32 s8, s8, 16384
s_waitcnt vmcnt(12)
v_perm_b32 v99, v252, v248, s16
v_perm_b32 v103, v252, v248, s17
v_perm_b32 v107, v253, v249, s16
v_perm_b32 v111, v253, v249, s17
v_perm_b32 v115, v254, v250, s16
v_perm_b32 v119, v254, v250, s17
v_perm_b32 v123, v255, v251, s16
v_perm_b32 v127, v255, v251, s17
s_waitcnt vmcnt(5)
buffer_load_dwordx4 v[176:179], v2, s[48:51], s8 offen offset:0 nt
s_waitcnt vmcnt(5)
buffer_load_dwordx4 v[180:183], v2, s[48:51], s8 offen offset:1024 nt
v_mfma_f32_16x16x32_bf16 v[56:59], v[44:47], v[96:99], v[56:59]
v_mfma_f32_16x16x32_bf16 v[60:63], v[44:47], v[100:103], v[60:63]
v_mfma_f32_16x16x32_bf16 v[64:67], v[44:47], v[104:107], v[64:67]
v_mfma_f32_16x16x32_bf16 v[68:71], v[44:47], v[108:111], v[68:71]
v_mfma_f32_16x16x32_bf16 v[72:75], v[44:47], v[112:115], v[72:75]
v_mfma_f32_16x16x32_bf16 v[76:79], v[44:47], v[116:119], v[76:79]
v_mfma_f32_16x16x32_bf16 v[80:83], v[44:47], v[120:123], v[80:83]
v_mfma_f32_16x16x32_bf16 v[84:87], v[44:47], v[124:127], v[84:87]
s_waitcnt vmcnt(12)
v_perm_b32 v96, v132, v128, s16
v_perm_b32 v100, v132, v128, s17
v_perm_b32 v104, v133, v129, s16
v_perm_b32 v108, v133, v129, s17
v_perm_b32 v112, v134, v130, s16
v_perm_b32 v116, v134, v130, s17
v_perm_b32 v120, v135, v131, s16
v_perm_b32 v124, v135, v131, s17
s_waitcnt vmcnt(5)
buffer_load_dwordx4 v[184:187], v2, s[48:51], s8 offen offset:2048 nt
s_waitcnt vmcnt(5)
buffer_load_dwordx4 v[188:191], v2, s[48:51], s8 offen offset:3072 nt
s_barrier
s_waitcnt vmcnt(12)
v_perm_b32 v97, v140, v136, s16
v_perm_b32 v101, v140, v136, s17
v_perm_b32 v105, v141, v137, s16
v_perm_b32 v109, v141, v137, s17
v_perm_b32 v113, v142, v138, s16
v_perm_b32 v117, v142, v138, s17
v_perm_b32 v121, v143, v139, s16
v_perm_b32 v125, v143, v139, s17
s_waitcnt vmcnt(10)
v_perm_b32 v98, v148, v144, s16
v_perm_b32 v102, v148, v144, s17
v_perm_b32 v106, v149, v145, s16
v_perm_b32 v110, v149, v145, s17
v_perm_b32 v114, v150, v146, s16
v_perm_b32 v118, v150, v146, s17
v_perm_b32 v122, v151, v147, s16
v_perm_b32 v126, v151, v147, s17
s_waitcnt vmcnt(8)
v_perm_b32 v99, v156, v152, s16
v_perm_b32 v103, v156, v152, s17
v_perm_b32 v107, v157, v153, s16
v_perm_b32 v111, v157, v153, s17
v_perm_b32 v115, v158, v154, s16
v_perm_b32 v119, v158, v154, s17
v_perm_b32 v123, v159, v155, s16
v_perm_b32 v127, v159, v155, s17
v_mfma_f32_16x16x32_bf16 v[56:59], v[48:51], v[96:99], v[56:59]
v_mfma_f32_16x16x32_bf16 v[60:63], v[48:51], v[100:103], v[60:63]
v_mfma_f32_16x16x32_bf16 v[64:67], v[48:51], v[104:107], v[64:67]
v_mfma_f32_16x16x32_bf16 v[68:71], v[48:51], v[108:111], v[68:71]
v_mfma_f32_16x16x32_bf16 v[72:75], v[48:51], v[112:115], v[72:75]
v_mfma_f32_16x16x32_bf16 v[76:79], v[48:51], v[116:119], v[76:79]
v_mfma_f32_16x16x32_bf16 v[80:83], v[48:51], v[120:123], v[80:83]
v_mfma_f32_16x16x32_bf16 v[84:87], v[48:51], v[124:127], v[84:87]
s_waitcnt vmcnt(6)
v_perm_b32 v96, v164, v160, s16
v_perm_b32 v100, v164, v160, s17
v_perm_b32 v104, v165, v161, s16
v_perm_b32 v108, v165, v161, s17
v_perm_b32 v112, v166, v162, s16
v_perm_b32 v116, v166, v162, s17
v_perm_b32 v120, v167, v163, s16
v_perm_b32 v124, v167, v163, s17
s_waitcnt vmcnt(4)
v_perm_b32 v97, v172, v168, s16
v_perm_b32 v101, v172, v168, s17
v_perm_b32 v105, v173, v169, s16
v_perm_b32 v109, v173, v169, s17
v_perm_b32 v113, v174, v170, s16
v_perm_b32 v117, v174, v170, s17
v_perm_b32 v121, v175, v171, s16
v_perm_b32 v125, v175, v171, s17
L_pad18:
s_cbranch_execz L_pad19
s_waitcnt vmcnt(2)
v_perm_b32 v98, v180, v176, s16
v_perm_b32 v102, v180, v176, s17
v_perm_b32 v106, v181, v177, s16
v_perm_b32 v110, v181, v177, s17
v_perm_b32 v114, v182, v178, s16
v_perm_b32 v118, v182, v178, s17
v_perm_b32 v122, v183, v179, s16
v_perm_b32 v126, v183, v179, s17
s_waitcnt vmcnt(0)
v_perm_b32 v99, v188, v184, s16
v_perm_b32 v103, v188, v184, s17
v_perm_b32 v107, v189, v185, s16
v_perm_b32 v111, v189, v185, s17
v_mfma_f32_16x16x32_bf16 v[56:59], v[52:55], v[96:99], v[56:59]
v_perm_b32 v115, v190, v186, s16
v_perm_b32 v119, v190, v186, s17
v_mfma_f32_16x16x32_bf16 v[60:63], v[52:55], v[100:103], v[60:63]
v_perm_b32 v123, v191, v187, s16
v_perm_b32 v127, v191, v187, s17
v_mfma_f32_16x16x32_bf16 v[64:67], v[52:55], v[104:107], v[64:67]
v_mfma_f32_16x16x32_bf16 v[68:71], v[52:55], v[108:111], v[68:71]
v_mfma_f32_16x16x32_bf16 v[72:75], v[52:55], v[112:115], v[72:75]
v_mfma_f32_16x16x32_bf16 v[76:79], v[52:55], v[116:119], v[76:79]
v_mfma_f32_16x16x32_bf16 v[80:83], v[52:55], v[120:123], v[80:83]
s_nop 0
ds_write2st64_b32 v15, v56, v60 offset0:0 offset1:1
v_mfma_f32_16x16x32_bf16 v[84:87], v[52:55], v[124:127], v[84:87]
s_nop 1
ds_write2st64_b32 v15, v64, v68 offset0:2 offset1:3
s_nop 0
ds_write2st64_b32 v15, v72, v76 offset0:4 offset1:5
s_nop 2
ds_write2st64_b32 v15, v80, v84 offset0:6 offset1:7
s_waitcnt lgkmcnt(0)
s_barrier
ds_read2st64_b32 v[4:5], v16 offset0:0 offset1:1
ds_read2st64_b32 v[6:7], v16 offset0:8 offset1:9
ds_read2st64_b32 v[8:9], v16 offset0:16 offset1:17
ds_read2st64_b32 v[10:11], v16 offset0:24 offset1:25
s_waitcnt lgkmcnt(2)
v_add_f32 v4, v4, v6
v_add_f32 v5, v5, v7
s_waitcnt lgkmcnt(0)
v_add_f32 v8, v8, v10
v_add_f32 v9, v9, v11
v_add_f32 v4, v4, v8
v_add_f32 v5, v5, v9
v_mul_f32 v4, v4, v18
v_mul_f32 v5, v5, v18
v_cvt_pk_bf16_f32 v4, v4, v5
v_min_u32 v4, -2, v4
s_cmp_eq_u32 s39, 0
s_cbranch_scc1 L_m1_s
buffer_store_dword v4, v17, s[80:83], s15 offen
L_m1_e:
s_endpgm
L_Hmid:
v_lshrrev_b32 v3, 4, v0
v_and_b32 v4, 15, v0
v_lshlrev_b32 v5, 4, v3
v_and_b32 v6, 7, v0
s_mov_b32 s12, 0xffff0000
s_lshl_b32 s29, s4, 2
s_add_u32 s29, s29, s18
s_cmp_gt_u32 s4, 7
s_subb_u32 s11, s4, 0
s_cmp_eq_u32 s4, 7
s_cselect_b32 s11, 7, s11
s_lshl_b32 s97, s11, 2
s_add_u32 s97, s97, s18
v_lshlrev_b32 v7, 1, v0
s_lshl_b32 s9, s17, 7
buffer_load_ushort v40, v7, s[40:43], s9 offen
v_lshlrev_b32 v25, 2, v0
v_lshlrev_b32 v19, 4, v0
v_lshlrev_b32 v20, 8, v4
v_add_u32 v20, v20, v5
v_add_u32 v7, 0x1000, v20
s_lshl_b32 s20, s29, 13
s_lshl_b32 s10, s6, 6
s_add_u32 s20, s20, s10
s_add_u32 s20, s20, 262144
s_lshl_b32 s21, s17, 13
s_lshl_b32 s10, s29, 8
s_add_u32 s21, s21, s10
s_add_u32 s21, s21, 131072
s_lshl_b32 s22, s17, 13
s_lshl_b32 s10, s6, 11
s_add_u32 s22, s22, s10
s_add_u32 s22, s22, 131072
v_lshlrev_b32 v23, 4, v4
v_lshl_add_u32 v23, v3, 2, v23
s_lshl_b32 s9, s6, 8
v_add_u32 v23, s9, v23
v_and_b32 v12, 3, v0
v_mov_b32 v92, 0x3f803f80
v_mov_b32 v93, 0x3f803f80
v_mov_b32 v94, 0x3f803f80
v_mov_b32 v95, 0x3f803f80
v_mov_b32 v96, 0x3f803f80
v_mov_b32 v97, 0x3f803f80
v_mov_b32 v98, 0x3f803f80
v_mov_b32 v99, 0x3f803f80
v_mul_u32_u24 v16, 10, v12
v_min_u32 v16, 22, v16
v_lshrrev_b32_e64 v16, v16, s96
v_mov_b32 v17, 1023
s_lshl_b32 s9, s6, 8
s_add_u32 s9, s9, 45568
v_add_u32 v26, s9, v25
v_lshlrev_b32 v27, 4, v4
v_lshl_add_u32 v27, v3, 11, v27
s_lshl_b32 s23, s97, 14
s_lshl_b32 s10, s17, 8
s_add_u32 s23, s23, s10
s_lshl_b32 s10, s6, 12
s_add_u32 s23, s23, s10
s_add_u32 s23, s23, 1048576
s_lshl_b32 s24, s97, 14
s_lshl_b32 s10, s6, 12
s_add_u32 s24, s24, s10
s_add_u32 s24, s24, 1048576
s_lshl_b32 s25, s97, 11
s_lshl_b32 s10, s17, 8
s_add_u32 s25, s25, s10
s_lshl_b32 s10, s6, 7
s_add_u32 s25, s25, s10
s_add_u32 s25, s25, 524288
v_mov_b32 v42, 0
ds_read_b32 v42, v42 offset:35968
s_lshl_b32 s9, s17, 1
s_sub_u32 s28, s11, s9
s_add_u32 s28, s28, 14
s_mul_i32 s9, s28, 37
s_lshr_b32 s9, s9, 8
s_mul_i32 s9, s9, 7
s_sub_u32 s28, s28, s9
s_lshl_b32 s28, s28, 2
s_add_u32 s28, s28, s18
s_lshl_b32 s15, s17, 3
s_add_u32 s15, s15, s28
v_and_b32 v12, 1, v0
v_lshrrev_b32 v36, 1, v0
v_lshlrev_b32 v36, 11, v36
v_lshl_add_u32 v36, v12, 4, v36
s_lshl_b32 s84, s15, 5
s_add_u32 s84, s84, 524288
v_lshl_add_u32 v37, v12, 2, v3
s_lshl_b32 s9, s28, 5
v_lshl_add_u32 v38, v37, 2, s9
v_lshlrev_b32 v37, 1, v37
s_lshl_b32 s15, s15, 4
L_pad19:
s_cbranch_execz L_pad20
s_waitcnt vmcnt(0) lgkmcnt(0)
v_lshlrev_b32 v40, 16, v40
v_readfirstlane_b32 s39, v42
v_lshrrev_b32 v14, 3, v0
v_mul_u32_u24 v14, 0xe00, v14
v_lshl_add_u32 v14, v6, 4, v14
s_mul_i32 s30, s17, 229376
s_mul_i32 s10, s6, 57344
s_add_u32 s30, s30, s10
s_lshl_b32 s10, s97, 7
s_add_u32 s30, s30, s10
s_cmp_eq_u32 s4, 7
s_cselect_b32 s30, 0x1000000, s30
s_add_u32 s31, s30, 27648
s_lshl_b32 s32, s97, 16
s_lshl_b32 s10, s6, 14
s_add_u32 s32, s32, s10
s_lshl_b32 s10, s17, 7
s_add_u32 s32, s32, s10
s_add_u32 s19, s32, 7168
s_lshl_b32 s13, s6, 11
s_add_u32 s85, s13, 16384
s_add_u32 s87, s13, 24640
s_add_u32 s33, s13, 47872
v_lshrrev_b32 v18, 3, v0
v_lshlrev_b32 v18, 10, v18
v_lshl_add_u32 v18, v6, 4, v18
v_lshrrev_b32 v1, 5, v0
v_lshl_add_u32 v1, v1, 3, v6
s_lshl_b32 s9, s6, 4
v_add_u32 v1, s9, v1
v_lshlrev_b32 v1, 1, v1
v_lshlrev_b32 v15, 10, v3
v_bfe_u32 v13, v0, 2, 2
v_lshl_add_u32 v15, v13, 7, v15
v_and_b32 v12, 3, v0
v_lshl_add_u32 v22, v12, 3, v15
s_lshl_b32 s9, s6, 6
v_add_u32 v39, s9, v22
s_lshl_b32 s9, s6, 12
v_add_u32 v22, s9, v22
v_and_b32 v12, 1, v0
v_lshl_add_u32 v15, v12, 3, v15
v_bfe_u32 v12, v0, 1, 1
v_mul_u32_u24 v12, 8256, v12
v_add_u32 v15, v15, v12
v_lshl_add_u32 v15, v3, 10, v15
s_lshl_b32 s9, s6, 5
v_add_u32 v15, s9, v15
s_cmp_lg_u32 s3, 0
s_cbranch_scc1 L_clre
v_mov_b32 v8, -1
v_mov_b32 v9, -1
v_mov_b32 v10, -1
v_mov_b32 v11, -1
v_lshlrev_b32 v12, 13, v3
v_lshl_add_u32 v12, v4, 4, v12
s_lshl_b32 s9, s4, 15
s_lshl_b32 s10, s5, 8
s_add_u32 s9, s9, s10
s_add_u32 s9, s9, 262144
s_cmp_eq_u32 s39, 0
s_cbranch_scc1 L_clr_s
buffer_store_dwordx4 v[8:11], v12, s[80:83], s9 offen
L_clr_e:
s_cmp_eq_u32 s4, 7
s_cbranch_scc1 L_clrf
s_add_u32 s9, s23, 8192
s_cmp_eq_u32 s39, 0
s_cbranch_scc1 L_clr2_s
buffer_store_dwordx4 v[8:11], v27, s[80:83], s23 offen
L_clr2_e:
s_cmp_eq_u32 s39, 0
s_cbranch_scc1 L_clr3_s
buffer_store_dwordx4 v[8:11], v27, s[80:83], s9 offen
L_clr3_e:
L_clrf:
s_waitcnt vmcnt(0)
L_clre:
s_barrier
s_barrier
s_cmp_lg_u32 s3, 0
s_cbranch_scc1 L_nolam
buffer_load_dword v172, v25, s[80:83], s25 offen sc1
buffer_load_dword v173, v25, s[80:83], s21 offen sc1
v_and_b32 v12, 3, v0
v_lshlrev_b32 v12, 4, v12
ds_read_b128 v[8:11], v12 offset:35840
ds_read_b128 v[164:167], v12 offset:35904
s_mov_b32 s14, 1069066811
s_lshl_b32 s11, s4, 10
s_lshl_b32 s10, s5, 5
s_add_u32 s11, s11, s10
s_add_u32 s11, s11, 65536
s_lshl_b32 s27, s4, 10
s_lshl_b32 s10, s18, 3
s_add_u32 s27, s27, s10
s_add_u32 s27, s27, 65536
s_waitcnt lgkmcnt(0)
v_max3_f32 v8, v8, v9, v10
v_max_f32 v8, v8, v11
v_cvt_pk_bf16_f32 v8, v8, v8
v_lshlrev_b32 v8, 16, v8
v_add_f32 v9, v164, v165
v_add_f32 v10, v166, v167
v_add_f32 v9, v9, v10
v_log_f32 v9, v9
v_mul_f32 v8, s14, v8
v_add_f32 v8, v8, v9
v_mov_b32 v9, s96
v_lshlrev_b32 v12, 3, v0
s_mov_b64 exec, 15
s_cmp_eq_u32 s39, 0
s_cbranch_scc1 L_lam_s
buffer_store_dwordx2 v[8:9], v12, s[80:83], s11 offen
L_lam_e:
s_mov_b64 exec, -1
v_and_b32 v12, 31, v0
v_lshlrev_b32 v12, 5, v12
s_mov_b32 s14, 0
L_lpoll:
buffer_load_dwordx2 v[10:11], v12, s[80:83], s27 offen sc1
s_add_u32 s14, s14, 1
s_cmp_gt_u32 s14, 262144
s_waitcnt vmcnt(0)
s_cbranch_scc1 L_ldone
v_cmp_ne_u32 vcc, s96, v11
s_cbranch_vccnz L_lpoll
L_ldone:
v_mov_b32 v8, v10
s_nop 1
v_max_f32_dpp v8, v8, v8 row_ror:8 row_mask:0xf bank_mask:0xf
s_nop 1
v_max_f32_dpp v8, v8, v8 row_ror:4 row_mask:0xf bank_mask:0xf
s_nop 1
v_max_f32_dpp v8, v8, v8 row_ror:2 row_mask:0xf bank_mask:0xf
s_nop 1
v_max_f32_dpp v8, v8, v8 row_ror:1 row_mask:0xf bank_mask:0xf
v_mov_b32 v9, v8
s_nop 1
v_permlane16_swap_b32 v9, v8
v_max_f32 v8, v8, v9
v_mov_b32 v9, v8
s_nop 1
v_permlane32_swap_b32 v9, v8
v_max_f32 v8, v8, v9
v_sub_f32 v10, v10, v8
v_exp_f32 v10, v10
s_nop 0
v_mov_b32 v8, v10
s_nop 1
v_add_f32_dpp v8, v8, v8 row_ror:8 row_mask:0xf bank_mask:0xf
s_nop 1
v_add_f32_dpp v8, v8, v8 row_ror:4 row_mask:0xf bank_mask:0xf
s_nop 1
v_add_f32_dpp v8, v8, v8 row_ror:2 row_mask:0xf bank_mask:0xf
s_nop 1
v_add_f32_dpp v8, v8, v8 row_ror:1 row_mask:0xf bank_mask:0xf
v_mov_b32 v9, v8
s_nop 1
v_permlane16_swap_b32 v9, v8
v_add_f32 v8, v8, v9
v_mov_b32 v9, v8
s_nop 1
v_permlane32_swap_b32 v9, v8
v_add_f32 v8, v8, v9
v_rcp_f32 v8, v8
v_add_f32 v10, v10, v10
v_mul_f32 v10, v10, v8
s_mov_b32 exec_hi, 0
ds_write_b32 v25, v10 offset:36096
s_mov_b64 exec, -1
L_nolam:
s_cmp_eq_u32 s4, 7
s_cbranch_scc1 L_noearly
s_cmp_lg_u32 s3, 1
s_cbranch_scc1 L_noearly3
s_lshl_b32 s9, s97, 14
s_lshl_b32 s10, s17, 11
s_add_u32 s9, s9, s10
s_add_u32 s9, s9, 1048576
buffer_load_dwordx4 v[100:103], v19, s[80:83], s9 offen offset:0 sc1
buffer_load_dwordx4 v[104:107], v19, s[80:83], s9 offen offset:1024 sc1
L_noearly3:
L_noearly:
s_waitcnt vmcnt(0) lgkmcnt(0)
L_pad20:
s_cbranch_execz L_pad21
s_barrier
s_lshl_b32 s9, s29, 17
s_lshl_b32 s10, s6, 15
s_add_u32 s9, s9, s10
s_lshl_b32 s10, s17, 7
s_add_u32 s9, s9, s10
s_lshl_b32 s10, s6, 12
s_add_u32 m0, s10, 0
s_nop 0
buffer_load_dwordx4 v18, s[56:59], s9 offen nt lds
s_add_u32 m0, m0, 1024
s_add_u32 s9, s9, 0x2000
buffer_load_dwordx4 v18, s[56:59], s9 offen nt lds
s_add_u32 m0, m0, 1024
s_add_u32 s9, s9, 0x2000
buffer_load_dwordx4 v18, s[56:59], s9 offen nt lds
s_add_u32 m0, m0, 1024
s_add_u32 s9, s9, 0x2000
buffer_load_dwordx4 v18, s[56:59], s9 offen nt lds
s_mov_b32 m0, s85
s_nop 0
buffer_load_dwordx4 v14, s[60:63], s30 offen nt lds
buffer_load_dwordx4 v14, s[60:63], s31 offen offset:1024 nt lds
ds_read_b128 v[28:31], v5 offset:36096
ds_read_b128 v[32:35], v5 offset:36160
s_barrier
s_waitcnt vmcnt(2)
ds_read_b64_tr_b16 v[44:45], v22 offset:0
ds_read_b64_tr_b16 v[46:47], v22 offset:512
ds_read_b64_tr_b16 v[48:49], v22 offset:32
ds_read_b64_tr_b16 v[50:51], v22 offset:544
ds_read_b64_tr_b16 v[52:53], v22 offset:64
ds_read_b64_tr_b16 v[54:55], v22 offset:576
ds_read_b64_tr_b16 v[56:57], v22 offset:96
ds_read_b64_tr_b16 v[58:59], v22 offset:608
s_mov_b32 s14, 0
L_p1:
buffer_load_dwordx4 v[100:103], v20, s[80:83], s20 offen sc1
buffer_load_dwordx4 v[104:107], v7, s[80:83], s20 offen sc1
s_add_u32 s14, s14, 1
s_cmp_gt_u32 s14, 262144
s_cbranch_scc1 L_p1_x
L_p1_c:
s_waitcnt vmcnt(1)
v_max_u32 v8, v100, v101
v_max_u32 v9, v102, v103
s_waitcnt vmcnt(0)
v_max3_u32 v8, v8, v104, v105
v_max3_u32 v9, v9, v106, v107
v_max_u32 v8, v8, v9
v_cmp_eq_u32 vcc, -1, v8
s_and_b64 exec, exec, vcc
s_cbranch_execnz L_p1
L_p1_x:
s_mov_b64 exec, -1
s_waitcnt vmcnt(0) lgkmcnt(0)
v_mfma_f32_16x16x32_bf16 v[132:135], v[100:103], v[44:47], 0
v_mfma_f32_16x16x32_bf16 v[136:139], v[104:107], v[44:47], 0
v_mfma_f32_16x16x32_bf16 v[140:143], v[100:103], v[48:51], 0
v_mfma_f32_16x16x32_bf16 v[144:147], v[104:107], v[48:51], 0
v_mfma_f32_16x16x32_bf16 v[148:151], v[100:103], v[52:55], 0
v_mfma_f32_16x16x32_bf16 v[152:155], v[104:107], v[52:55], 0
v_mfma_f32_16x16x32_bf16 v[156:159], v[100:103], v[56:59], 0
s_nop 1
v_mul_f32 v8, v28, v132
v_fmac_f32 v8, v29, v133
v_mfma_f32_16x16x32_bf16 v[160:163], v[104:107], v[56:59], 0
v_fmac_f32 v8, v30, v134
v_fmac_f32 v8, v31, v135
s_mov_b32 m0, s87
s_nop 0
buffer_load_dwordx4 v14, s[64:67], s30 offen nt lds
buffer_load_dwordx4 v14, s[64:67], s31 offen offset:1024 nt lds
s_mov_b32 m0, s33
s_nop 0
buffer_load_dwordx4 v18, s[68:71], s32 offen nt lds
buffer_load_dwordx4 v18, s[68:71], s19 offen offset:1024 nt lds
v_fmac_f32 v8, v32, v136
v_fmac_f32 v8, v33, v137
v_fmac_f32 v8, v34, v138
v_fmac_f32 v8, v35, v139
v_pk_mul_f32 v[140:141], v[28:29], v[140:141]
v_pk_fma_f32 v[140:141], v[30:31], v[142:143], v[140:141]
v_pk_fma_f32 v[140:141], v[32:33], v[144:145], v[140:141]
v_pk_fma_f32 v[140:141], v[34:35], v[146:147], v[140:141]
v_pk_mul_f32 v[148:149], v[28:29], v[148:149]
v_pk_fma_f32 v[148:149], v[30:31], v[150:151], v[148:149]
v_pk_fma_f32 v[148:149], v[32:33], v[152:153], v[148:149]
v_pk_fma_f32 v[148:149], v[34:35], v[154:155], v[148:149]
v_pk_mul_f32 v[156:157], v[28:29], v[156:157]
v_pk_fma_f32 v[156:157], v[30:31], v[158:159], v[156:157]
v_pk_fma_f32 v[156:157], v[32:33], v[160:161], v[156:157]
v_pk_fma_f32 v[156:157], v[34:35], v[162:163], v[156:157]
v_add_f32 v10, v148, v149
v_add_f32 v9, v140, v141
v_add_f32 v11, v156, v157
v_permlane32_swap_b32 v8, v10
v_add_f32 v8, v8, v10
v_permlane32_swap_b32 v9, v11
v_add_f32 v9, v9, v11
s_nop 1
v_permlane16_swap_b32 v8, v9
v_add_f32 v8, v8, v9
ds_write_b32 v26, v8
s_waitcnt lgkmcnt(0)
s_barrier
s_cmp_lg_u32 s3, 0
s_cbranch_scc1 L_nowpub
ds_read2st64_b32 v[8:9], v25 offset0:178 offset1:179
ds_read2st64_b32 v[10:11], v25 offset0:180 offset1:181
s_waitcnt lgkmcnt(0)
v_add_f32 v8, v8, v9
v_add_f32 v10, v10, v11
v_add_f32 v8, v8, v10
v_bfi_b32 v8, v17, v16, v8
buffer_store_dword v8, v25, s[80:83], s21 offen sc1
L_nowpub:
s_cmp_eq_u32 s4, 7
s_cbranch_scc1 L_Hend
L_pad21:
s_cbranch_execz L_pad22
s_mov_b32 s14, 0
s_sleep 13
buffer_load_dwordx4 v[164:167], v19, s[80:83], s22 offen offset:0 sc1
buffer_load_dwordx4 v[168:171], v19, s[80:83], s22 offen offset:1024 sc1
s_branch L_p2_c
L_p2:
buffer_load_dwordx4 v[164:167], v19, s[80:83], s22 offen offset:0 sc1
buffer_load_dwordx4 v[168:171], v19, s[80:83], s22 offen offset:1024 sc1
s_add_u32 s14, s14, 1
s_cmp_gt_u32 s14, 262144
s_cbranch_scc1 L_p2_x
L_p2_c:
s_waitcnt vmcnt(1)
v_xor_b32 v164, s34, v164
v_xor_b32 v165, s35, v165
v_xor_b32 v166, s36, v166
v_xor_b32 v167, s37, v167
v_or_b32 v8, v164, v165
v_or_b32 v9, v166, v167
s_waitcnt vmcnt(0)
v_xor_b32 v168, s34, v168
v_xor_b32 v169, s35, v169
v_xor_b32 v170, s36, v170
v_xor_b32 v171, s37, v171
v_or3_b32 v8, v8, v168, v169
v_or3_b32 v9, v9, v170, v171
v_bitop3_b32 v8, v8, v9, v17 bitop3:0xa8
v_cmp_ne_u32 vcc, 0, v8
s_and_b64 exec, exec, vcc
s_cbranch_execnz L_p2
L_p2_x:
s_mov_b64 exec, -1
v_add_f32 v164, v164, v168
v_add_f32 v165, v165, v169
v_add_f32 v166, v166, v170
v_add_f32 v167, v167, v171
s_nop 0
v_permlane32_swap_b32 v164, v166
v_permlane32_swap_b32 v165, v167
v_add_f32 v164, v164, v166
v_add_f32 v165, v165, v167
s_nop 1
v_permlane16_swap_b32 v164, v165
v_add_f32 v8, v164, v165
ds_write_b32 v23, v8 offset:46592
s_waitcnt lgkmcnt(0)
s_barrier
ds_read2st64_b32 v[8:9], v25 offset0:182 offset1:183
ds_read2st64_b32 v[10:11], v25 offset0:184 offset1:185
ds_read_b64_tr_b16 v[60:61], v15 offset:16384
ds_read_b64_tr_b16 v[62:63], v15 offset:16896
ds_read_b64_tr_b16 v[68:69], v15 offset:16400
ds_read_b64_tr_b16 v[70:71], v15 offset:16912
ds_read_b64_tr_b16 v[64:65], v15 offset:17408
ds_read_b64_tr_b16 v[66:67], v15 offset:17920
ds_read_b64_tr_b16 v[72:73], v15 offset:17424
ds_read_b64_tr_b16 v[74:75], v15 offset:17936
s_waitcnt lgkmcnt(9)
v_add_f32 v8, v8, v40
v_add_f32 v8, v8, v9
s_waitcnt lgkmcnt(8)
v_add_f32 v10, v10, v11
v_add_f32 v21, v8, v10
s_nop 1
v_mov_b32_dpp v9, v21 quad_perm:[1,0,3,2] row_mask:0xf bank_mask:0xf
v_cvt_pk_bf16_f32 v8, v21, v9
s_mov_b32 exec_lo, 0xdddddddd
s_mov_b32 exec_hi, 0xdddddddd
v_mov_b32_dpp v92, v8 row_newbcast:0 row_mask:0xf bank_mask:0xf
v_mov_b32_dpp v93, v8 row_newbcast:2 row_mask:0xf bank_mask:0xf
v_mov_b32_dpp v94, v8 row_newbcast:4 row_mask:0xf bank_mask:0xf
v_mov_b32_dpp v95, v8 row_newbcast:6 row_mask:0xf bank_mask:0xf
v_mov_b32_dpp v96, v8 row_newbcast:8 row_mask:0xf bank_mask:0xf
v_mov_b32_dpp v97, v8 row_newbcast:10 row_mask:0xf bank_mask:0xf
v_mov_b32_dpp v98, v8 row_newbcast:12 row_mask:0xf bank_mask:0xf
v_mov_b32_dpp v99, v8 row_newbcast:14 row_mask:0xf bank_mask:0xf
s_mov_b64 exec, -1
v_mfma_f32_16x16x32_bf16 v[140:143], v[92:95], v[92:95], 0
s_waitcnt lgkmcnt(4)
v_mfma_f32_16x16x32_bf16 v[132:135], v[92:95], v[60:63], 0
v_mfma_f32_16x16x32_bf16 v[136:139], v[92:95], v[68:71], 0
v_mfma_f32_16x16x32_bf16 v[140:143], v[96:99], v[96:99], v[140:143]
s_waitcnt lgkmcnt(0)
v_mfma_f32_16x16x32_bf16 v[132:135], v[96:99], v[64:67], v[132:135]
v_mfma_f32_16x16x32_bf16 v[136:139], v[96:99], v[72:75], v[136:139]
s_mov_b32 exec_hi, 0
s_nop 3
v_mov_b32_dpp v10, v140 quad_perm:[0,0,2,3] row_mask:0xf bank_mask:0xf
v_mov_b32_dpp v11, v141 quad_perm:[0,0,2,3] row_mask:0xf bank_mask:0xf
v_min_u32 v10, -2, v10
v_min_u32 v11, -2, v11
v_mov_b32_dpp v132, v136 quad_perm:[0,1,2,3] row_mask:2 bank_mask:0xf
v_mov_b32_dpp v133, v137 quad_perm:[0,1,2,3] row_mask:2 bank_mask:0xf
v_min_u32 v8, -2, v132
v_min_u32 v9, -2, v133
s_cmp_eq_u32 s39, 0
s_cbranch_scc1 L_mf_s
buffer_store_dwordx4 v[8:11], v27, s[80:83], s23 offen
L_mf_e:
s_mov_b64 exec, -1
L_pad22:
s_cbranch_execz L_pad23
s_mov_b32 s13, 0x3b000000
s_mov_b32 s16, 0xc0135761
s_mov_b32 s26, 0xbdd2d3e8
s_mov_b32 s14, 0
buffer_load_dwordx4 v[100:103], v19, s[80:83], s24 offen offset:0 sc1
buffer_load_dwordx4 v[104:107], v19, s[80:83], s24 offen offset:1024 sc1
buffer_load_dwordx4 v[108:111], v19, s[80:83], s24 offen offset:2048 sc1
buffer_load_dwordx4 v[112:115], v19, s[80:83], s24 offen offset:3072 sc1
ds_read_b64_tr_b16 v[76:77], v39 offset:47872
ds_read_b64_tr_b16 v[78:79], v39 offset:48384
ds_read_b64_tr_b16 v[80:81], v39 offset:51968
ds_read_b64_tr_b16 v[82:83], v39 offset:52480
ds_read_b64_tr_b16 v[84:85], v39 offset:47904
ds_read_b64_tr_b16 v[86:87], v39 offset:48416
ds_read_b64_tr_b16 v[88:89], v39 offset:52000
ds_read_b64_tr_b16 v[90:91], v39 offset:52512
s_branch L_p25_c
L_p25:
buffer_load_dwordx4 v[100:103], v19, s[80:83], s24 offen offset:0 sc1
buffer_load_dwordx4 v[104:107], v19, s[80:83], s24 offen offset:1024 sc1
buffer_load_dwordx4 v[108:111], v19, s[80:83], s24 offen offset:2048 sc1
buffer_load_dwordx4 v[112:115], v19, s[80:83], s24 offen offset:3072 sc1
s_add_u32 s14, s14, 1
s_cmp_gt_u32 s14, 262144
s_cbranch_scc1 L_p25_x
L_p25_c:
s_waitcnt vmcnt(3)
v_max_u32 v12, v100, v101
v_max_u32 v13, v102, v103
s_waitcnt vmcnt(2)
v_max3_u32 v12, v12, v104, v105
v_max3_u32 v13, v13, v106, v107
s_waitcnt vmcnt(1)
v_max3_u32 v12, v12, v108, v109
v_max3_u32 v13, v13, v110, v111
s_waitcnt vmcnt(0)
v_max3_u32 v12, v12, v112, v113
v_max3_u32 v13, v13, v114, v115
v_max_u32 v12, v12, v13
v_cmp_eq_u32 vcc, -1, v12
s_and_b64 exec, exec, vcc
s_cbranch_execnz L_p25
L_p25_x:
s_mov_b64 exec, -1
s_waitcnt vmcnt(0)
v_add_f32 v100, v100, v104
v_add_f32 v108, v108, v112
v_add_f32 v101, v101, v105
v_add_f32 v109, v109, v113
v_add_f32 v102, v102, v106
v_add_f32 v110, v110, v114
v_add_f32 v103, v103, v107
v_add_f32 v111, v111, v115
v_permlane32_swap_b32 v100, v108
v_permlane32_swap_b32 v101, v109
v_permlane32_swap_b32 v102, v110
v_permlane32_swap_b32 v103, v111
v_add_f32 v100, v100, v108
v_add_f32 v101, v101, v109
v_add_f32 v102, v102, v110
v_add_f32 v103, v103, v111
v_mov_b32 v104, v100
v_mov_b32 v105, v101
v_mov_b32 v106, v102
v_mov_b32 v107, v103
s_nop 1
v_permlane16_swap_b32 v103, v107
v_permlane16_swap_b32 v102, v106
v_permlane16_swap_b32 v100, v104
v_permlane16_swap_b32 v101, v105
v_add_f32 v103, v103, v107
v_add_f32 v102, v102, v106
v_add_f32 v100, v100, v104
v_add_f32 v101, v101, v105
v_mul_f32 v13, s13, v103
v_mul_f32 v14, v13, v13
v_fma_f32 v12, v102, s13, -v14
v_max_f32 v12, 0, v12
v_add_f32 v12, 0x3727c5ac, v12
v_rsq_f32 v12, v12
v_fma_f32 v14, -v13, v101, v100
v_mul_f32 v14, v14, v12
v_mul_f32 v15, v14, v14
v_mov_b32 v12, s16
v_fmac_f32 v12, s26, v15
v_mul_f32 v12, v12, v14
v_exp_f32 v12, v12
v_mov_b32_dpp v15, v14 row_ror:8 row_mask:0xf bank_mask:0xf
v_add_f32 v12, 1.0, v12
v_rcp_f32 v12, v12
v_mul_f32 v14, v14, v15
s_mov_b32 exec_lo, 0xff
s_mov_b32 exec_hi, 0xff
v_mul_f32 v14, v14, v12
v_cvt_pk_bf16_f32 v14, v14, v14
ds_write_b16 v1, v14 offset:47616
s_mov_b64 exec, -1
s_waitcnt lgkmcnt(0)
s_barrier
s_cmp_gt_u32 s3, 1
s_cbranch_scc1 L_R
ds_read_b128 v[100:103], v5 offset:47616
ds_read_b128 v[104:107], v5 offset:47680
s_waitcnt lgkmcnt(1)
v_mfma_f32_16x16x32_bf16 v[132:135], v[100:103], v[76:79], 0
v_mfma_f32_16x16x32_bf16 v[136:139], v[100:103], v[84:87], 0
s_waitcnt lgkmcnt(0)
v_mfma_f32_16x16x32_bf16 v[132:135], v[104:107], v[80:83], v[132:135]
v_mfma_f32_16x16x32_bf16 v[136:139], v[104:107], v[88:91], v[136:139]
s_mov_b32 exec_hi, 0
s_nop 6
v_mov_b32_dpp v132, v136 quad_perm:[0,1,2,3] row_mask:2 bank_mask:0xf
v_bfi_b32 v8, v17, v16, v132
buffer_store_dword v8, v25, s[80:83], s25 offen sc1
s_branch L_Hend
L_R:
s_cmp_eq_u32 s3, 2
s_cbranch_scc1 L_R2
s_cmp_lg_u32 s2, 0
s_cbranch_scc1 L_Hend
s_mov_b64 exec, 1
v_mov_b32 v9, s96
v_mov_b32 v10, 102400
buffer_store_dword v9, v10, s[80:83], 0 offen sc1
s_branch L_Hend
L_R2:
s_cmp_gt_u32 s28, 7
s_cbranch_scc1 L_Hend
L_pad23:
s_cbranch_execz L_warm_end
ds_bpermute_b32 v21, v38, v21
v_mov_b32 v168, 0
v_mov_b32 v169, 0
v_mov_b32 v170, 0
v_mov_b32 v171, 0
s_waitcnt lgkmcnt(0)
v_cvt_pk_bf16_f32 v21, v21, v21
v_lshlrev_b32 v21, 16, v21
s_mov_b32 exec_hi, 0x00ffffff
s_mov_b32 s14, 0
s_sleep 10
L_p3:
buffer_load_dwordx4 v[168:171], v36, s[80:83], s84 offen sc1
s_add_u32 s14, s14, 1
s_cmp_gt_u32 s14, 262144
s_cbranch_scc1 L_p3_x
L_p3_c:
s_waitcnt vmcnt(0)
v_xor_b32 v168, s34, v168
v_xor_b32 v169, s35, v169
v_xor_b32 v170, s36, v170
v_xor_b32 v171, s37, v171
v_or_b32 v8, v168, v169
v_or_b32 v9, v170, v171
v_bitop3_b32 v8, v8, v9, v17 bitop3:0xa8
v_cmp_ne_u32 vcc, 0, v8
s_and_b64 exec, exec, vcc
s_cbranch_execnz L_p3
L_p3_x:
s_mov_b64 exec, -1
v_permlane32_swap_b32 v168, v170
v_permlane32_swap_b32 v169, v171
v_add_f32 v168, v168, v170
v_add_f32 v169, v169, v171
s_nop 1
v_permlane16_swap_b32 v168, v169
v_add_f32 v8, v168, v169
s_nop 1
v_add_f32_dpp v8, v8, v8 row_ror:8 row_mask:0xf bank_mask:0xf
s_nop 1
v_add_f32_dpp v8, v8, v8 row_ror:4 row_mask:0xf bank_mask:0xf
s_nop 1
v_add_f32_dpp v8, v8, v8 quad_perm:[2,3,0,1] row_mask:0xf bank_mask:0xf
v_cvt_pk_bf16_f32 v8, v8, v8
v_lshlrev_b32 v8, 16, v8
v_add_f32 v8, v8, v21
s_mov_b32 exec_lo, 0x00030003
s_mov_b32 exec_hi, 0x00030003
v_cvt_pk_bf16_f32 v8, v8, v8
buffer_store_short v8, v37, s[72:75], s15 offen
L_Hend:
L_end:
s_endpgm
L_m1_s:
buffer_store_dword v4, v17, s[80:83], s15 offen sc1
s_branch L_m1_e
L_clr_s:
buffer_store_dwordx4 v[8:11], v12, s[80:83], s9 offen sc1
s_branch L_clr_e
L_clr2_s:
buffer_store_dwordx4 v[8:11], v27, s[80:83], s23 offen sc1
s_branch L_clr2_e
L_clr3_s:
buffer_store_dwordx4 v[8:11], v27, s[80:83], s9 offen sc1
s_branch L_clr3_e
L_lam_s:
buffer_store_dwordx2 v[8:9], v12, s[80:83], s11 offen sc1
s_branch L_lam_e
L_mf_s:
buffer_store_dwordx4 v[8:11], v27, s[80:83], s23 offen sc1
s_branch L_mf_e
.section .rodata,"a"
.p2align 6
.amdhsa_kernel sequential_preLN__gqa_block_cached__glu_gated_geglu__decode_kernel
  .amdhsa_next_free_vgpr 256
  .amdhsa_next_free_sgpr 98
  .amdhsa_accum_offset 256
  .amdhsa_group_segment_fixed_size 0
  .amdhsa_kernarg_size 96
  .amdhsa_user_sgpr_count 2
  .amdhsa_user_sgpr_kernarg_segment_ptr 1
  .amdhsa_system_sgpr_workgroup_id_x 1
  .amdhsa_float_denorm_mode_32 3
.end_amdhsa_kernel
```
